```python
import torch

def _softmax(x, axis=-1):
    return torch.softmax(x, dim=axis)
def _gelu(x):
    return torch.nn.functional.gelu(x, approximate="tanh")
def _silu(x):
    return torch.nn.functional.silu(x)
def _sigmoid(x):
    return torch.sigmoid(x)
def _layernorm(x, axis=-1, eps=1e-5):
    m = x.mean(dim=axis, keepdim=True)
    v = x.var(dim=axis, keepdim=True, unbiased=False)
    return (x - m) / torch.sqrt(v + eps)
def _scatter_add(tgt, idx, src, axis=0):
    return tgt.clone().index_add_(axis, idx, src)
def _segment_sum(src, seg, n):
    out = torch.zeros((n,) + src.shape[1:], dtype=src.dtype)
    return out.index_add_(0, seg, src)
def _pad(x, pw):
    flat = tuple(v for pair in reversed(pw) for v in pair)
    return torch.nn.functional.pad(x, flat)

kernel_name = 'standalone__gqa_softmax__near_ridge'

def setup_inputs():

    _w = (lambda a: (lambda t: t.to(torch.bfloat16) if t.is_floating_point() else t)(torch.as_tensor(a)))
    B, Hq, Hkv, Sq, Sk, D = 16, 32, 8, 96, 512, 128
    return {
        "q": _w((lambda *s: torch.randn(*s, dtype=torch.bfloat16) * 0.8)(B, Hq, Sq, D)),
        "k": _w((lambda *s: torch.randn(*s, dtype=torch.bfloat16) * 0.8)(B, Hkv, Sk, D)),
        "v": _w((lambda *s: torch.randn(*s, dtype=torch.bfloat16) * 0.05)(B, Hkv, Sk, D)),
    }

def reference(q, k, v):
    B, Hq, Sq, D = q.shape
    Hkv = k.shape[1]
    rep = Hq // Hkv
    k = (lambda x, n, axis: torch.repeat_interleave(x, n, dim=axis))(k, rep, axis=1)
    v = (lambda x, n, axis: torch.repeat_interleave(x, n, dim=axis))(v, rep, axis=1)
    scale = D ** -0.5
    scores = torch.einsum("bhqd,bhkd->bhqk", q, k) * scale
    p = _softmax(scores, axis=-1)
    return torch.einsum("bhqk,bhkd->bhqd", p, v)
```

```asm
; @launch grid=(256,1,1) block=(256,1,1) lds=163840
.amdgcn_target "amdgcn-amd-amdhsa--gfx950"
.text
.globl standalone__gqa_softmax__near_ridge_kernel
.p2align 8
.type standalone__gqa_softmax__near_ridge_kernel,@function
standalone__gqa_softmax__near_ridge_kernel:
    s_cmp_ge_u32 s2, 256
    s_cbranch_scc1 L_end
    s_load_dwordx8 s[20:27], s[0:1], 0
    v_lshrrev_b32 v1, 6, v0
    s_and_b32 s34, s2, 7
    v_readfirstlane_b32 s31, v1
    s_cmp_ge_u32 s2, 16
    s_cbranch_scc1 L_nopf
    s_nop 1
    s_cmp_lg_u32 s31, 0
    s_cbranch_scc1 L_nopf
    s_getpc_b64 s[56:57]
    v_lshlrev_b32 v7, 6, v0
    global_load_dword v248, v7, s[56:57] offset:0
    v_add_u32 v7, 4096, v7
    global_load_dword v249, v7, s[56:57] offset:0
    v_add_u32 v7, 4096, v7
    global_load_dword v250, v7, s[56:57] offset:0
    v_add_u32 v7, 4096, v7
L_nopf:
    s_lshr_b32 s35, s2, 4
    s_lshl_b32 s35, s35, 3
    s_or_b32 s34, s34, s35
    s_bfe_u32 s35, s2, 0x10003
    s_lshl_b32 s32, s34, 17
    s_mul_i32 s28, s34, 98304
    s_mul_i32 s35, s35, 49152
    s_add_u32 s28, s28, s35
    v_and_b32 v0, 63, v0
    v_lshrrev_b32 v1, 4, v0
    v_and_b32 v2, 15, v0
    s_mul_i32 s35, s31, 12288
    s_add_u32 s28, s28, s35
    s_lshl_b32 s33, s31, 12
    v_lshlrev_b32 v3, 4, v1
    v_lshl_add_u32 v226, v2, 8, v3
    v_lshlrev_b32 v3, 1, v1
    v_xor_b32 v3, v2, v3
    v_lshlrev_b32 v3, 4, v3
    v_lshl_add_u32 v3, v1, 8, v3
    v_add_u32 v224, s33, v3
    v_xor_b32 v225, 128, v224
    s_add_u32 s29, s28, 4096
    s_add_u32 s30, s28, 8192
    s_waitcnt lgkmcnt(0)
    s_mov_b32 s4, s20
    s_and_b32 s5, s21, 0xffff
    s_mov_b32 s6, 12582912
    s_mov_b32 s7, 0x20000
    buffer_load_dwordx4 v[104:107], v226, s[4:7], s28 offen offset:0
    buffer_load_dwordx4 v[108:111], v226, s[4:7], s28 offen offset:64
    buffer_load_dwordx4 v[112:115], v226, s[4:7], s28 offen offset:128
    buffer_load_dwordx4 v[116:119], v226, s[4:7], s28 offen offset:192
    s_mov_b32 s8, s22
    s_and_b32 s9, s23, 0xffff
    s_mov_b32 s10, 16777216
    s_mov_b32 s11, 0x20000
    s_add_u32 s34, s32, 0
    s_add_u32 m0, s33, 0
    s_nop 0
    buffer_load_dwordx4 v224, s[8:11], s34 offen offset:0  lds
    buffer_load_dwordx4 v225, s[8:11], s34 offen offset:1024  lds
    buffer_load_dwordx4 v224, s[8:11], s34 offen offset:2048  lds
    buffer_load_dwordx4 v225, s[8:11], s34 offen offset:3072  lds
    s_mov_b32 s12, s24
    s_and_b32 s13, s25, 0xffff
    s_mov_b32 s14, 16777216
    s_mov_b32 s15, 0x20000
    s_mov_b32 s16, s26
    s_and_b32 s17, s27, 0xffff
    s_mov_b32 s18, 12582912
    s_mov_b32 s19, 0x20000
    v_and_b32 v4, 7, v0
    v_lshlrev_b32 v4, 1, v4
    v_xor_b32 v4, v1, v4
    v_lshlrev_b32 v4, 4, v4
    v_lshl_add_u32 v4, v2, 8, v4
    v_xor_b32 v212, 0, v4
    v_xor_b32 v213, 64, v4
    v_xor_b32 v214, 128, v4
    v_xor_b32 v215, 192, v4
    v_bfe_u32 v4, v0, 2, 2
    v_lshl_add_u32 v4, v1, 2, v4
    v_and_b32 v5, 7, v4
    v_lshlrev_b32 v5, 1, v5
    v_bfe_u32 v6, v0, 1, 1
    v_xor_b32 v5, v5, v6
    v_lshlrev_b32 v5, 4, v5
    v_and_b32 v6, 1, v0
    v_lshl_add_u32 v5, v6, 3, v5
    v_lshl_add_u32 v4, v4, 8, v5
    v_add_u32 v4, 81920, v4
    v_xor_b32 v216, 0, v4
    v_xor_b32 v217, 32, v4
    v_xor_b32 v218, 64, v4
    v_xor_b32 v219, 96, v4
    v_xor_b32 v220, 128, v4
    v_xor_b32 v221, 160, v4
    v_xor_b32 v222, 192, v4
    v_xor_b32 v223, 224, v4
    v_and_b32 v4, 1, v1
    v_lshlrev_b32 v4, 5, v4
    v_lshrrev_b32 v5, 1, v1
    v_lshl_add_u32 v4, v5, 4, v4
    v_lshl_add_u32 v227, v2, 8, v4
    s_mov_b32 s44, 0x3e0293ee
    s_mov_b32 s45, 0x3e0293ee
    s_mov_b32 s58, 0x4b800000
    s_mov_b32 s59, 0xbe0293ee
    s_mov_b32 s43, 16384
    s_mov_b32 s46, -65536
    s_mov_b32 s47, 0x30000
    s_mov_b32 s36, 2
    s_add_u32 s38, s32, 49152
    s_add_u32 s37, s32, 81920
    s_add_u32 s40, s33, 131072
    s_add_u32 s39, s33, 0
    v_mov_b32 v4, 0x3f803f80
    v_accvgpr_write_b32 a128, v4
    v_accvgpr_write_b32 a129, v4
    v_accvgpr_write_b32 a130, v4
    v_accvgpr_write_b32 a131, v4
    s_waitcnt vmcnt(4)
    buffer_load_dwordx4 v[120:123], v226, s[4:7], s29 offen offset:0
    buffer_load_dwordx4 v[124:127], v226, s[4:7], s29 offen offset:64
    buffer_load_dwordx4 v[128:131], v226, s[4:7], s29 offen offset:128
    buffer_load_dwordx4 v[132:135], v226, s[4:7], s29 offen offset:192
    v_lshlrev_b32 v72, 16, v104
    v_and_b32 v73, 0xffff0000, v104
    v_lshlrev_b32 v74, 16, v105
    v_and_b32 v75, 0xffff0000, v105
    v_lshlrev_b32 v76, 16, v106
    v_and_b32 v77, 0xffff0000, v106
    v_lshlrev_b32 v78, 16, v107
    v_and_b32 v79, 0xffff0000, v107
    v_lshlrev_b32 v80, 16, v108
    v_and_b32 v81, 0xffff0000, v108
    v_lshlrev_b32 v82, 16, v109
    v_and_b32 v83, 0xffff0000, v109
    v_lshlrev_b32 v84, 16, v110
    v_and_b32 v85, 0xffff0000, v110
    v_lshlrev_b32 v86, 16, v111
    v_and_b32 v87, 0xffff0000, v111
    v_lshlrev_b32 v88, 16, v112
    v_and_b32 v89, 0xffff0000, v112
    v_lshlrev_b32 v90, 16, v113
    v_and_b32 v91, 0xffff0000, v113
    v_lshlrev_b32 v92, 16, v114
    v_and_b32 v93, 0xffff0000, v114
    v_lshlrev_b32 v94, 16, v115
    v_and_b32 v95, 0xffff0000, v115
    v_lshlrev_b32 v96, 16, v116
    v_and_b32 v97, 0xffff0000, v116
    v_lshlrev_b32 v98, 16, v117
    v_and_b32 v99, 0xffff0000, v117
    v_lshlrev_b32 v100, 16, v118
    v_and_b32 v101, 0xffff0000, v118
    v_lshlrev_b32 v102, 16, v119
    v_and_b32 v103, 0xffff0000, v119
    v_pk_mul_f32 v[72:73], v[72:73], s[44:45]
    v_pk_mul_f32 v[74:75], v[74:75], s[44:45]
    v_pk_mul_f32 v[76:77], v[76:77], s[44:45]
    v_pk_mul_f32 v[78:79], v[78:79], s[44:45]
    v_pk_mul_f32 v[80:81], v[80:81], s[44:45]
    v_pk_mul_f32 v[82:83], v[82:83], s[44:45]
    v_pk_mul_f32 v[84:85], v[84:85], s[44:45]
    v_pk_mul_f32 v[86:87], v[86:87], s[44:45]
    v_pk_mul_f32 v[88:89], v[88:89], s[44:45]
    v_pk_mul_f32 v[90:91], v[90:91], s[44:45]
    v_pk_mul_f32 v[92:93], v[92:93], s[44:45]
    v_pk_mul_f32 v[94:95], v[94:95], s[44:45]
    v_pk_mul_f32 v[96:97], v[96:97], s[44:45]
    v_pk_mul_f32 v[98:99], v[98:99], s[44:45]
    v_pk_mul_f32 v[100:101], v[100:101], s[44:45]
    v_pk_mul_f32 v[102:103], v[102:103], s[44:45]
    v_cvt_pk_bf16_f32 v104, v72, v73
    v_cvt_pk_bf16_f32 v105, v74, v75
    v_cvt_pk_bf16_f32 v106, v76, v77
    v_cvt_pk_bf16_f32 v107, v78, v79
    v_cvt_pk_bf16_f32 v108, v80, v81
    v_cvt_pk_bf16_f32 v109, v82, v83
    v_cvt_pk_bf16_f32 v110, v84, v85
    v_cvt_pk_bf16_f32 v111, v86, v87
    v_cvt_pk_bf16_f32 v112, v88, v89
    v_cvt_pk_bf16_f32 v113, v90, v91
    v_cvt_pk_bf16_f32 v114, v92, v93
    v_cvt_pk_bf16_f32 v115, v94, v95
    v_cvt_pk_bf16_f32 v116, v96, v97
    v_cvt_pk_bf16_f32 v117, v98, v99
    v_cvt_pk_bf16_f32 v118, v100, v101
    v_cvt_pk_bf16_f32 v119, v102, v103
    s_waitcnt vmcnt(4)
    s_barrier
    s_add_u32 s34, s32, 16384
    s_add_u32 m0, s33, 16384
    s_nop 0
    buffer_load_dwordx4 v224, s[8:11], s34 offen offset:0  lds
    buffer_load_dwordx4 v225, s[8:11], s34 offen offset:1024  lds
    buffer_load_dwordx4 v224, s[8:11], s34 offen offset:2048  lds
    buffer_load_dwordx4 v225, s[8:11], s34 offen offset:3072  lds
    ds_read_b128 a[144:147], v212 offset:0
    ds_read_b128 a[160:163], v212 offset:4096
    ds_read_b128 a[148:151], v213 offset:0
    ds_read_b128 a[164:167], v213 offset:4096
    ds_read_b128 a[152:155], v214 offset:0
    ds_read_b128 a[168:171], v214 offset:4096
    ds_read_b128 a[156:159], v215 offset:0
    ds_read_b128 a[172:175], v215 offset:4096
    ds_read_b128 a[176:179], v212 offset:8192
    ds_read_b128 a[192:195], v212 offset:12288
    ds_read_b128 a[180:183], v213 offset:8192
    ds_read_b128 a[196:199], v213 offset:12288
    ds_read_b128 a[184:187], v214 offset:8192
    ds_read_b128 a[200:203], v214 offset:12288
    ds_read_b128 a[188:191], v215 offset:8192
    ds_read_b128 a[204:207], v215 offset:12288
    buffer_load_dwordx4 v[136:139], v226, s[4:7], s30 offen offset:0
    buffer_load_dwordx4 v[140:143], v226, s[4:7], s30 offen offset:64
    buffer_load_dwordx4 v[144:147], v226, s[4:7], s30 offen offset:128
    buffer_load_dwordx4 v[148:151], v226, s[4:7], s30 offen offset:192
    s_waitcnt lgkmcnt(15)
    v_mfma_f32_16x16x32_bf16 v[152:155], a[144:147], v[104:107], 0
    s_waitcnt lgkmcnt(14)
    v_mfma_f32_16x16x32_bf16 v[156:159], a[160:163], v[104:107], 0
    s_waitcnt lgkmcnt(13)
    v_mfma_f32_16x16x32_bf16 v[152:155], a[148:151], v[108:111], v[152:155]
    s_waitcnt lgkmcnt(12)
    v_mfma_f32_16x16x32_bf16 v[156:159], a[164:167], v[108:111], v[156:159]
    s_waitcnt lgkmcnt(11)
    v_mfma_f32_16x16x32_bf16 v[152:155], a[152:155], v[112:115], v[152:155]
    s_waitcnt lgkmcnt(10)
    v_mfma_f32_16x16x32_bf16 v[156:159], a[168:171], v[112:115], v[156:159]
    s_waitcnt lgkmcnt(9)
    v_mfma_f32_16x16x32_bf16 v[152:155], a[156:159], v[116:119], v[152:155]
    s_waitcnt lgkmcnt(8)
    v_mfma_f32_16x16x32_bf16 v[156:159], a[172:175], v[116:119], v[156:159]
    s_waitcnt lgkmcnt(7)
    v_mfma_f32_16x16x32_bf16 v[160:163], a[176:179], v[104:107], 0
    s_waitcnt lgkmcnt(6)
    v_mfma_f32_16x16x32_bf16 v[164:167], a[192:195], v[104:107], 0
    s_waitcnt lgkmcnt(5)
    v_mfma_f32_16x16x32_bf16 v[160:163], a[180:183], v[108:111], v[160:163]
    s_waitcnt lgkmcnt(4)
    v_mfma_f32_16x16x32_bf16 v[164:167], a[196:199], v[108:111], v[164:167]
    s_waitcnt lgkmcnt(3)
    v_mfma_f32_16x16x32_bf16 v[160:163], a[184:187], v[112:115], v[160:163]
    s_waitcnt lgkmcnt(2)
    v_mfma_f32_16x16x32_bf16 v[164:167], a[200:203], v[112:115], v[164:167]
    s_waitcnt lgkmcnt(1)
    v_mfma_f32_16x16x32_bf16 v[160:163], a[188:191], v[116:119], v[160:163]
    s_waitcnt lgkmcnt(0)
    v_mfma_f32_16x16x32_bf16 v[164:167], a[204:207], v[116:119], v[164:167]
    v_max3_f32 v228, v152, v153, v154
    v_max3_f32 v229, v156, v157, v158
    v_max3_f32 v228, v228, v155, v159
    s_nop 2
    v_max3_f32 v229, v229, v160, v161
    v_max3_f32 v228, v228, v162, v163
    v_max3_f32 v229, v229, v164, v165
    v_max3_f32 v228, v228, v166, v167
    v_max_f32 v228, v228, v229
    v_mov_b32 v229, v228
    s_nop 1
    v_permlane16_swap_b32 v228, v229
    v_max_f32 v228, v228, v229
    v_mov_b32 v229, v228
    s_nop 1
    v_permlane32_swap_b32 v228, v229
    v_max_f32 v228, v228, v229
    v_sub_f32 v200, 0, v228
    v_sub_f32 v201, 0, v228
    v_sub_f32 v202, 0, v228
    v_sub_f32 v203, 0, v228
    v_add_f32 v152, v152, v200
    v_exp_f32 v152, v152
    v_add_f32 v153, v153, v200
    v_exp_f32 v153, v153
    s_nop 0
    v_cvt_pk_bf16_f32 v232, v152, v153
    v_add_f32 v160, v160, v200
    v_exp_f32 v160, v160
    v_add_f32 v161, v161, v200
    v_exp_f32 v161, v161
    s_nop 0
    v_cvt_pk_bf16_f32 v236, v160, v161
    v_add_f32 v154, v154, v200
    v_exp_f32 v154, v154
    v_add_f32 v155, v155, v200
    v_exp_f32 v155, v155
    s_nop 0
    v_cvt_pk_bf16_f32 v233, v154, v155
    v_add_f32 v162, v162, v200
    v_exp_f32 v162, v162
    v_add_f32 v163, v163, v200
    v_exp_f32 v163, v163
    s_nop 0
    v_cvt_pk_bf16_f32 v237, v162, v163
    v_add_f32 v156, v156, v200
    v_exp_f32 v156, v156
    v_add_f32 v157, v157, v200
    v_exp_f32 v157, v157
    s_nop 0
    v_cvt_pk_bf16_f32 v234, v156, v157
    v_add_f32 v164, v164, v200
    v_exp_f32 v164, v164
    v_add_f32 v165, v165, v200
    v_exp_f32 v165, v165
    s_nop 0
    v_cvt_pk_bf16_f32 v238, v164, v165
    v_add_f32 v158, v158, v200
    v_exp_f32 v158, v158
    v_add_f32 v159, v159, v200
    v_exp_f32 v159, v159
    s_nop 0
    v_cvt_pk_bf16_f32 v235, v158, v159
    v_add_f32 v166, v166, v200
    v_exp_f32 v166, v166
    v_add_f32 v167, v167, v200
    v_exp_f32 v167, v167
    s_nop 0
    v_cvt_pk_bf16_f32 v239, v166, v167
    s_waitcnt vmcnt(8)
    s_add_u32 s34, s32, 0
    s_add_u32 m0, s33, 81920
    s_nop 0
    buffer_load_dwordx4 v224, s[12:15], s34 offen offset:0  lds
    buffer_load_dwordx4 v225, s[12:15], s34 offen offset:1024  lds
    buffer_load_dwordx4 v224, s[12:15], s34 offen offset:2048  lds
    buffer_load_dwordx4 v225, s[12:15], s34 offen offset:3072  lds
    v_mfma_f32_16x16x32_bf16 v[168:171], a[144:147], v[120:123], 0
    v_lshlrev_b32 v72, 16, v120
    v_and_b32 v73, 0xffff0000, v120
    v_mfma_f32_16x16x32_bf16 v[172:175], a[160:163], v[120:123], 0
    v_lshlrev_b32 v74, 16, v121
    v_and_b32 v75, 0xffff0000, v121
    v_mfma_f32_16x16x32_bf16 v[168:171], a[148:151], v[124:127], v[168:171]
    v_lshlrev_b32 v76, 16, v122
    v_and_b32 v77, 0xffff0000, v122
    v_mfma_f32_16x16x32_bf16 v[172:175], a[164:167], v[124:127], v[172:175]
    v_lshlrev_b32 v78, 16, v123
    v_and_b32 v79, 0xffff0000, v123
    v_mfma_f32_16x16x32_bf16 v[168:171], a[152:155], v[128:131], v[168:171]
    v_lshlrev_b32 v80, 16, v124
    v_and_b32 v81, 0xffff0000, v124
    v_mfma_f32_16x16x32_bf16 v[172:175], a[168:171], v[128:131], v[172:175]
    v_lshlrev_b32 v82, 16, v125
    v_and_b32 v83, 0xffff0000, v125
    v_mfma_f32_16x16x32_bf16 v[168:171], a[156:159], v[132:135], v[168:171]
    v_lshlrev_b32 v84, 16, v126
    v_and_b32 v85, 0xffff0000, v126
    v_mfma_f32_16x16x32_bf16 v[172:175], a[172:175], v[132:135], v[172:175]
    v_lshlrev_b32 v86, 16, v127
    v_and_b32 v87, 0xffff0000, v127
    v_mfma_f32_16x16x32_bf16 v[152:155], a[176:179], v[120:123], 0
    v_lshlrev_b32 v88, 16, v128
    v_and_b32 v89, 0xffff0000, v128
    v_mfma_f32_16x16x32_bf16 v[156:159], a[192:195], v[120:123], 0
    v_lshlrev_b32 v90, 16, v129
    v_and_b32 v91, 0xffff0000, v129
    v_mfma_f32_16x16x32_bf16 v[152:155], a[180:183], v[124:127], v[152:155]
    v_lshlrev_b32 v92, 16, v130
    v_and_b32 v93, 0xffff0000, v130
    v_mfma_f32_16x16x32_bf16 v[156:159], a[196:199], v[124:127], v[156:159]
    v_lshlrev_b32 v94, 16, v131
    v_and_b32 v95, 0xffff0000, v131
    v_mfma_f32_16x16x32_bf16 v[152:155], a[184:187], v[128:131], v[152:155]
    v_lshlrev_b32 v96, 16, v132
    v_and_b32 v97, 0xffff0000, v132
    v_mfma_f32_16x16x32_bf16 v[156:159], a[200:203], v[128:131], v[156:159]
    v_lshlrev_b32 v98, 16, v133
    v_and_b32 v99, 0xffff0000, v133
    v_mfma_f32_16x16x32_bf16 v[152:155], a[188:191], v[132:135], v[152:155]
    v_lshlrev_b32 v100, 16, v134
    v_and_b32 v101, 0xffff0000, v134
    v_mfma_f32_16x16x32_bf16 v[156:159], a[204:207], v[132:135], v[156:159]
    v_lshlrev_b32 v102, 16, v135
    v_and_b32 v103, 0xffff0000, v135
    v_pk_mul_f32 v[72:73], v[72:73], s[44:45]
    v_pk_mul_f32 v[74:75], v[74:75], s[44:45]
    v_pk_mul_f32 v[76:77], v[76:77], s[44:45]
    v_pk_mul_f32 v[78:79], v[78:79], s[44:45]
    v_pk_mul_f32 v[80:81], v[80:81], s[44:45]
    v_pk_mul_f32 v[82:83], v[82:83], s[44:45]
    v_pk_mul_f32 v[84:85], v[84:85], s[44:45]
    v_pk_mul_f32 v[86:87], v[86:87], s[44:45]
    v_pk_mul_f32 v[88:89], v[88:89], s[44:45]
    v_pk_mul_f32 v[90:91], v[90:91], s[44:45]
    v_pk_mul_f32 v[92:93], v[92:93], s[44:45]
    v_pk_mul_f32 v[94:95], v[94:95], s[44:45]
    v_pk_mul_f32 v[96:97], v[96:97], s[44:45]
    v_pk_mul_f32 v[98:99], v[98:99], s[44:45]
    v_pk_mul_f32 v[100:101], v[100:101], s[44:45]
    v_pk_mul_f32 v[102:103], v[102:103], s[44:45]
    v_cvt_pk_bf16_f32 v120, v72, v73
    v_cvt_pk_bf16_f32 v121, v74, v75
    v_cvt_pk_bf16_f32 v122, v76, v77
    v_cvt_pk_bf16_f32 v123, v78, v79
    v_cvt_pk_bf16_f32 v124, v80, v81
    v_cvt_pk_bf16_f32 v125, v82, v83
    v_cvt_pk_bf16_f32 v126, v84, v85
    v_cvt_pk_bf16_f32 v127, v86, v87
    v_cvt_pk_bf16_f32 v128, v88, v89
    v_cvt_pk_bf16_f32 v129, v90, v91
    v_cvt_pk_bf16_f32 v130, v92, v93
    v_cvt_pk_bf16_f32 v131, v94, v95
    v_cvt_pk_bf16_f32 v132, v96, v97
    v_cvt_pk_bf16_f32 v133, v98, v99
    v_cvt_pk_bf16_f32 v134, v100, v101
    v_cvt_pk_bf16_f32 v135, v102, v103
    v_max3_f32 v228, v168, v169, v170
    v_max3_f32 v229, v172, v173, v174
    v_max3_f32 v228, v228, v171, v175
    v_max3_f32 v229, v229, v152, v153
    v_max3_f32 v228, v228, v154, v155
    v_max3_f32 v229, v229, v156, v157
    v_max3_f32 v228, v228, v158, v159
    v_max_f32 v228, v228, v229
    v_mov_b32 v229, v228
    s_nop 1
    v_permlane16_swap_b32 v228, v229
    v_max_f32 v228, v228, v229
    v_mov_b32 v229, v228
    s_nop 1
    v_permlane32_swap_b32 v228, v229
    v_max_f32 v228, v228, v229
    v_mul_f32 v204, s59, v228
    v_mul_f32 v205, s59, v228
    v_mul_f32 v206, s59, v228
    v_mul_f32 v207, s59, v228
    v_fma_f32 v168, v168, s44, v204
    v_exp_f32 v168, v168
    v_fma_f32 v169, v169, s44, v204
    v_exp_f32 v169, v169
    s_nop 0
    v_cvt_pk_bf16_f32 v240, v168, v169
    v_fma_f32 v152, v152, s44, v204
    v_exp_f32 v152, v152
    v_fma_f32 v153, v153, s44, v204
    v_exp_f32 v153, v153
    s_nop 0
    v_cvt_pk_bf16_f32 v244, v152, v153
    v_fma_f32 v170, v170, s44, v204
    v_exp_f32 v170, v170
    v_fma_f32 v171, v171, s44, v204
    v_exp_f32 v171, v171
    s_nop 0
    v_cvt_pk_bf16_f32 v241, v170, v171
    v_fma_f32 v154, v154, s44, v204
    v_exp_f32 v154, v154
    v_fma_f32 v155, v155, s44, v204
    v_exp_f32 v155, v155
    s_nop 0
    v_cvt_pk_bf16_f32 v245, v154, v155
    v_fma_f32 v172, v172, s44, v204
    v_exp_f32 v172, v172
    v_fma_f32 v173, v173, s44, v204
    v_exp_f32 v173, v173
    s_nop 0
    v_cvt_pk_bf16_f32 v242, v172, v173
    v_fma_f32 v156, v156, s44, v204
    v_exp_f32 v156, v156
    v_fma_f32 v157, v157, s44, v204
    v_exp_f32 v157, v157
    s_nop 0
    v_cvt_pk_bf16_f32 v246, v156, v157
    v_fma_f32 v174, v174, s44, v204
    v_exp_f32 v174, v174
    v_fma_f32 v175, v175, s44, v204
    v_exp_f32 v175, v175
    s_nop 0
    v_cvt_pk_bf16_f32 v243, v174, v175
    v_fma_f32 v158, v158, s44, v204
    v_exp_f32 v158, v158
    v_fma_f32 v159, v159, s44, v204
    v_exp_f32 v159, v159
    s_nop 0
    v_cvt_pk_bf16_f32 v247, v158, v159
    s_waitcnt vmcnt(8)
    s_barrier
    s_add_u32 s34, s32, 16384
    s_add_u32 m0, s33, 98304
    s_nop 0
    buffer_load_dwordx4 v224, s[12:15], s34 offen offset:0  lds
    buffer_load_dwordx4 v225, s[12:15], s34 offen offset:1024  lds
    buffer_load_dwordx4 v224, s[12:15], s34 offen offset:2048  lds
    buffer_load_dwordx4 v225, s[12:15], s34 offen offset:3072  lds
    v_add_u32 v212, 16384, v212
    ds_read_b128 a[0:3], v212 offset:0
    ds_read_b128 a[16:19], v212 offset:4096
    v_add_u32 v213, 16384, v213
    ds_read_b128 a[4:7], v213 offset:0
    ds_read_b128 a[20:23], v213 offset:4096
    v_add_u32 v214, 16384, v214
    ds_read_b128 a[8:11], v214 offset:0
    ds_read_b128 a[24:27], v214 offset:4096
    v_add_u32 v215, 16384, v215
    ds_read_b128 a[12:15], v215 offset:0
    ds_read_b128 a[28:31], v215 offset:4096
    s_waitcnt lgkmcnt(0)
    v_mfma_f32_16x16x32_bf16 v[160:163], a[0:3], v[104:107], v[200:203]
    v_mfma_f32_16x16x32_bf16 v[164:167], a[16:19], v[104:107], v[200:203]
    v_mfma_f32_16x16x32_bf16 v[160:163], a[4:7], v[108:111], v[160:163]
    ds_read_b128 a[32:35], v212 offset:8192
    v_mfma_f32_16x16x32_bf16 v[164:167], a[20:23], v[108:111], v[164:167]
    ds_read_b128 a[48:51], v212 offset:12288
    v_mfma_f32_16x16x32_bf16 v[160:163], a[8:11], v[112:115], v[160:163]
    ds_read_b128 a[36:39], v213 offset:8192
    v_mfma_f32_16x16x32_bf16 v[164:167], a[24:27], v[112:115], v[164:167]
    ds_read_b128 a[52:55], v213 offset:12288
    v_mfma_f32_16x16x32_bf16 v[160:163], a[12:15], v[116:119], v[160:163]
    ds_read_b128 a[40:43], v214 offset:8192
    v_mfma_f32_16x16x32_bf16 v[164:167], a[28:31], v[116:119], v[164:167]
    ds_read_b128 a[56:59], v214 offset:12288
    ds_read_b128 a[44:47], v215 offset:8192
    ds_read_b128 a[60:63], v215 offset:12288
    s_waitcnt lgkmcnt(0)
    v_mfma_f32_16x16x32_bf16 v[168:171], a[32:35], v[104:107], v[200:203]
    v_mfma_f32_16x16x32_bf16 v[172:175], a[48:51], v[104:107], v[200:203]
    v_mfma_f32_16x16x32_bf16 v[168:171], a[36:39], v[108:111], v[168:171]
    v_exp_f32 v160, v160
    v_mfma_f32_16x16x32_bf16 v[172:175], a[52:55], v[108:111], v[172:175]
    v_exp_f32 v161, v161
    v_mfma_f32_16x16x32_bf16 v[168:171], a[40:43], v[112:115], v[168:171]
    v_exp_f32 v162, v162
    v_mfma_f32_16x16x32_bf16 v[172:175], a[56:59], v[112:115], v[172:175]
    v_exp_f32 v163, v163
    v_mfma_f32_16x16x32_bf16 v[168:171], a[44:47], v[116:119], v[168:171]
    v_exp_f32 v164, v164
    v_mfma_f32_16x16x32_bf16 v[172:175], a[60:63], v[116:119], v[172:175]
    v_exp_f32 v165, v165
    v_mfma_f32_16x16x32_bf16 v[152:155], a[0:3], v[120:123], v[204:207]
    v_exp_f32 v166, v166
    v_mfma_f32_16x16x32_bf16 v[156:159], a[16:19], v[120:123], v[204:207]
    v_exp_f32 v167, v167
    v_mfma_f32_16x16x32_bf16 v[152:155], a[4:7], v[124:127], v[152:155]
    v_cvt_pk_bf16_f32 v176, v160, v161
    v_cvt_pk_bf16_f32 v177, v162, v163
    v_mfma_f32_16x16x32_bf16 v[156:159], a[20:23], v[124:127], v[156:159]
    v_cvt_pk_bf16_f32 v178, v164, v165
    v_cvt_pk_bf16_f32 v179, v166, v167
    v_mfma_f32_16x16x32_bf16 v[152:155], a[8:11], v[128:131], v[152:155]
    v_exp_f32 v168, v168
    v_mfma_f32_16x16x32_bf16 v[156:159], a[24:27], v[128:131], v[156:159]
    v_exp_f32 v169, v169
    v_mfma_f32_16x16x32_bf16 v[152:155], a[12:15], v[132:135], v[152:155]
    v_exp_f32 v170, v170
    v_mfma_f32_16x16x32_bf16 v[156:159], a[28:31], v[132:135], v[156:159]
    v_exp_f32 v171, v171
    v_mfma_f32_16x16x32_bf16 v[160:163], a[32:35], v[120:123], v[204:207]
    v_exp_f32 v172, v172
    v_mfma_f32_16x16x32_bf16 v[164:167], a[48:51], v[120:123], v[204:207]
    v_exp_f32 v173, v173
    v_mfma_f32_16x16x32_bf16 v[160:163], a[36:39], v[124:127], v[160:163]
    v_exp_f32 v174, v174
    v_mfma_f32_16x16x32_bf16 v[164:167], a[52:55], v[124:127], v[164:167]
    v_exp_f32 v175, v175
    v_mfma_f32_16x16x32_bf16 v[160:163], a[40:43], v[128:131], v[160:163]
    v_cvt_pk_bf16_f32 v188, v168, v169
    v_cvt_pk_bf16_f32 v189, v170, v171
    v_mfma_f32_16x16x32_bf16 v[164:167], a[56:59], v[128:131], v[164:167]
    v_cvt_pk_bf16_f32 v190, v172, v173
    v_cvt_pk_bf16_f32 v191, v174, v175
    v_mfma_f32_16x16x32_bf16 v[160:163], a[44:47], v[132:135], v[160:163]
    v_exp_f32 v152, v152
    v_mfma_f32_16x16x32_bf16 v[164:167], a[60:63], v[132:135], v[164:167]
    s_waitcnt vmcnt(8)
    s_add_u32 s34, s32, 32768
    s_add_u32 m0, s33, 32768
    s_nop 0
    buffer_load_dwordx4 v224, s[8:11], s34 offen offset:0  lds
    buffer_load_dwordx4 v225, s[8:11], s34 offen offset:1024  lds
    buffer_load_dwordx4 v224, s[8:11], s34 offen offset:2048  lds
    buffer_load_dwordx4 v225, s[8:11], s34 offen offset:3072  lds
    v_exp_f32 v153, v153
    v_mfma_f32_16x16x32_bf16 v[168:171], a[144:147], v[136:139], 0
    v_exp_f32 v154, v154
    v_mfma_f32_16x16x32_bf16 v[172:175], a[160:163], v[136:139], 0
    v_exp_f32 v155, v155
    v_mfma_f32_16x16x32_bf16 v[168:171], a[148:151], v[140:143], v[168:171]
    v_exp_f32 v156, v156
    v_mfma_f32_16x16x32_bf16 v[172:175], a[164:167], v[140:143], v[172:175]
    v_exp_f32 v157, v157
    v_mfma_f32_16x16x32_bf16 v[168:171], a[152:155], v[144:147], v[168:171]
    v_exp_f32 v158, v158
    v_mfma_f32_16x16x32_bf16 v[172:175], a[168:171], v[144:147], v[172:175]
    v_exp_f32 v159, v159
    v_mfma_f32_16x16x32_bf16 v[168:171], a[156:159], v[148:151], v[168:171]
    v_cvt_pk_bf16_f32 v180, v152, v153
    v_cvt_pk_bf16_f32 v181, v154, v155
    v_mfma_f32_16x16x32_bf16 v[172:175], a[172:175], v[148:151], v[172:175]
    v_cvt_pk_bf16_f32 v182, v156, v157
    v_cvt_pk_bf16_f32 v183, v158, v159
    v_mfma_f32_16x16x32_bf16 v[152:155], a[176:179], v[136:139], 0
    v_exp_f32 v160, v160
    v_mfma_f32_16x16x32_bf16 v[156:159], a[192:195], v[136:139], 0
    v_exp_f32 v161, v161
    v_mfma_f32_16x16x32_bf16 v[152:155], a[180:183], v[140:143], v[152:155]
    v_exp_f32 v162, v162
    v_mfma_f32_16x16x32_bf16 v[156:159], a[196:199], v[140:143], v[156:159]
    v_exp_f32 v163, v163
    v_mfma_f32_16x16x32_bf16 v[152:155], a[184:187], v[144:147], v[152:155]
    v_lshlrev_b32 v72, 16, v136
    v_and_b32 v73, 0xffff0000, v136
    v_mfma_f32_16x16x32_bf16 v[156:159], a[200:203], v[144:147], v[156:159]
    v_lshlrev_b32 v74, 16, v137
    v_and_b32 v75, 0xffff0000, v137
    v_mfma_f32_16x16x32_bf16 v[152:155], a[188:191], v[148:151], v[152:155]
    v_lshlrev_b32 v76, 16, v138
    v_and_b32 v77, 0xffff0000, v138
    v_mfma_f32_16x16x32_bf16 v[156:159], a[204:207], v[148:151], v[156:159]
    v_lshlrev_b32 v78, 16, v139
    v_and_b32 v79, 0xffff0000, v139
    v_max3_f32 v228, v168, v169, v170
    v_max3_f32 v229, v172, v173, v174
    v_max3_f32 v228, v228, v171, v175
    v_max3_f32 v229, v229, v152, v153
    v_max3_f32 v228, v228, v154, v155
    s_nop 0
    v_max3_f32 v229, v229, v156, v157
    v_max3_f32 v228, v228, v158, v159
    v_max_f32 v228, v228, v229
    v_mov_b32 v229, v228
    s_nop 1
    v_permlane16_swap_b32 v228, v229
    v_max_f32 v228, v228, v229
    v_mov_b32 v229, v228
    s_nop 1
    v_permlane32_swap_b32 v228, v229
    v_max_f32 v228, v228, v229
    v_mul_f32 v208, s59, v228
    v_mul_f32 v209, s59, v228
    v_mul_f32 v210, s59, v228
    v_mul_f32 v211, s59, v228
    s_waitcnt vmcnt(8)
    s_barrier
    s_add_u32 s34, s32, 49152
    s_add_u32 m0, s33, 49152
    s_nop 0
    buffer_load_dwordx4 v224, s[8:11], s34 offen offset:0  lds
    buffer_load_dwordx4 v225, s[8:11], s34 offen offset:1024  lds
    buffer_load_dwordx4 v224, s[8:11], s34 offen offset:2048  lds
    buffer_load_dwordx4 v225, s[8:11], s34 offen offset:3072  lds
    ds_read_b64_tr_b16 a[64:65], v216 offset:0
    ds_read_b64_tr_b16 a[66:67], v216 offset:4096
    ds_read_b64_tr_b16 a[68:69], v217 offset:0
    ds_read_b64_tr_b16 a[70:71], v217 offset:4096
    ds_read_b64_tr_b16 a[72:73], v218 offset:0
    ds_read_b64_tr_b16 a[74:75], v218 offset:4096
    ds_read_b64_tr_b16 a[76:77], v219 offset:0
    ds_read_b64_tr_b16 a[78:79], v219 offset:4096
    ds_read_b64_tr_b16 a[80:81], v220 offset:0
    ds_read_b64_tr_b16 a[82:83], v220 offset:4096
    ds_read_b64_tr_b16 a[84:85], v221 offset:0
    ds_read_b64_tr_b16 a[86:87], v221 offset:4096
    ds_read_b64_tr_b16 a[88:89], v222 offset:0
    ds_read_b64_tr_b16 a[90:91], v222 offset:4096
    ds_read_b64_tr_b16 a[92:93], v223 offset:0
    ds_read_b64_tr_b16 a[94:95], v223 offset:4096
    s_waitcnt lgkmcnt(0)
    v_mfma_f32_16x16x32_bf16 v[8:11], a[64:67], v[232:235], 0
    v_pk_mul_f32 v[72:73], v[72:73], s[44:45]
    v_pk_mul_f32 v[74:75], v[74:75], s[44:45]
    v_mfma_f32_16x16x32_bf16 v[12:15], a[68:71], v[232:235], 0
    v_pk_mul_f32 v[76:77], v[76:77], s[44:45]
    v_pk_mul_f32 v[78:79], v[78:79], s[44:45]
    v_mfma_f32_16x16x32_bf16 v[16:19], a[72:75], v[232:235], 0
    ds_read_b64_tr_b16 a[96:97], v216 offset:8192
    ds_read_b64_tr_b16 a[98:99], v216 offset:12288
    v_mfma_f32_16x16x32_bf16 v[20:23], a[76:79], v[232:235], 0
    ds_read_b64_tr_b16 a[100:101], v217 offset:8192
    ds_read_b64_tr_b16 a[102:103], v217 offset:12288
    v_mfma_f32_16x16x32_bf16 v[24:27], a[80:83], v[232:235], 0
    ds_read_b64_tr_b16 a[104:105], v218 offset:8192
    ds_read_b64_tr_b16 a[106:107], v218 offset:12288
    v_mfma_f32_16x16x32_bf16 v[28:31], a[84:87], v[232:235], 0
    ds_read_b64_tr_b16 a[108:109], v219 offset:8192
    ds_read_b64_tr_b16 a[110:111], v219 offset:12288
    v_mfma_f32_16x16x32_bf16 v[32:35], a[88:91], v[232:235], 0
    ds_read_b64_tr_b16 a[112:113], v220 offset:8192
    ds_read_b64_tr_b16 a[114:115], v220 offset:12288
    v_mfma_f32_16x16x32_bf16 v[36:39], a[92:95], v[232:235], 0
    ds_read_b64_tr_b16 a[116:117], v221 offset:8192
    ds_read_b64_tr_b16 a[118:119], v221 offset:12288
    v_mfma_f32_16x16x32_bf16 a[132:135], a[128:131], v[232:235], 0
    ds_read_b64_tr_b16 a[120:121], v222 offset:8192
    ds_read_b64_tr_b16 a[122:123], v222 offset:12288
    ds_read_b64_tr_b16 a[124:125], v223 offset:8192
    ds_read_b64_tr_b16 a[126:127], v223 offset:12288
    s_waitcnt lgkmcnt(0)
    v_mfma_f32_16x16x32_bf16 v[8:11], a[96:99], v[236:239], v[8:11]
    v_cvt_pk_bf16_f32 v136, v72, v73
    v_cvt_pk_bf16_f32 v137, v74, v75
    v_mfma_f32_16x16x32_bf16 v[12:15], a[100:103], v[236:239], v[12:15]
    v_cvt_pk_bf16_f32 v138, v76, v77
    v_cvt_pk_bf16_f32 v139, v78, v79
    v_mfma_f32_16x16x32_bf16 v[16:19], a[104:107], v[236:239], v[16:19]
    v_exp_f32 v164, v164
    v_mfma_f32_16x16x32_bf16 v[20:23], a[108:111], v[236:239], v[20:23]
    v_exp_f32 v165, v165
    v_mfma_f32_16x16x32_bf16 v[24:27], a[112:115], v[236:239], v[24:27]
    v_exp_f32 v166, v166
    v_mfma_f32_16x16x32_bf16 v[28:31], a[116:119], v[236:239], v[28:31]
    v_exp_f32 v167, v167
    v_mfma_f32_16x16x32_bf16 v[32:35], a[120:123], v[236:239], v[32:35]
    v_cvt_pk_bf16_f32 v192, v160, v161
    v_cvt_pk_bf16_f32 v193, v162, v163
    v_mfma_f32_16x16x32_bf16 v[36:39], a[124:127], v[236:239], v[36:39]
    v_cvt_pk_bf16_f32 v194, v164, v165
    v_cvt_pk_bf16_f32 v195, v166, v167
    v_mfma_f32_16x16x32_bf16 a[132:135], a[128:131], v[236:239], a[132:135]
    v_lshlrev_b32 v80, 16, v140
    v_and_b32 v81, 0xffff0000, v140
    v_mfma_f32_16x16x32_bf16 v[160:163], a[0:3], v[136:139], v[208:211]
    v_lshlrev_b32 v82, 16, v141
    v_and_b32 v83, 0xffff0000, v141
    v_lshlrev_b32 v84, 16, v142
    v_and_b32 v85, 0xffff0000, v142
    v_lshlrev_b32 v86, 16, v143
    v_and_b32 v87, 0xffff0000, v143
    v_pk_mul_f32 v[80:81], v[80:81], s[44:45]
    v_pk_mul_f32 v[82:83], v[82:83], s[44:45]
    v_pk_mul_f32 v[84:85], v[84:85], s[44:45]
    v_pk_mul_f32 v[86:87], v[86:87], s[44:45]
    v_cvt_pk_bf16_f32 v140, v80, v81
    v_cvt_pk_bf16_f32 v141, v82, v83
    v_cvt_pk_bf16_f32 v142, v84, v85
    v_cvt_pk_bf16_f32 v143, v86, v87
    v_mfma_f32_16x16x32_bf16 v[164:167], a[16:19], v[136:139], v[208:211]
    v_lshlrev_b32 v88, 16, v144
    v_and_b32 v89, 0xffff0000, v144
    v_mfma_f32_16x16x32_bf16 v[160:163], a[4:7], v[140:143], v[160:163]
    v_lshlrev_b32 v90, 16, v145
    v_and_b32 v91, 0xffff0000, v145
    v_lshlrev_b32 v92, 16, v146
    v_and_b32 v93, 0xffff0000, v146
    v_lshlrev_b32 v94, 16, v147
    v_and_b32 v95, 0xffff0000, v147
    v_pk_mul_f32 v[88:89], v[88:89], s[44:45]
    v_pk_mul_f32 v[90:91], v[90:91], s[44:45]
    v_pk_mul_f32 v[92:93], v[92:93], s[44:45]
    v_pk_mul_f32 v[94:95], v[94:95], s[44:45]
    v_cvt_pk_bf16_f32 v144, v88, v89
    v_cvt_pk_bf16_f32 v145, v90, v91
    v_cvt_pk_bf16_f32 v146, v92, v93
    v_cvt_pk_bf16_f32 v147, v94, v95
    v_mfma_f32_16x16x32_bf16 v[164:167], a[20:23], v[140:143], v[164:167]
    v_lshlrev_b32 v96, 16, v148
    v_and_b32 v97, 0xffff0000, v148
    v_mfma_f32_16x16x32_bf16 v[160:163], a[8:11], v[144:147], v[160:163]
    v_lshlrev_b32 v98, 16, v149
    v_and_b32 v99, 0xffff0000, v149
    v_lshlrev_b32 v100, 16, v150
    v_and_b32 v101, 0xffff0000, v150
    v_lshlrev_b32 v102, 16, v151
    v_and_b32 v103, 0xffff0000, v151
    v_pk_mul_f32 v[96:97], v[96:97], s[44:45]
    v_pk_mul_f32 v[98:99], v[98:99], s[44:45]
    v_pk_mul_f32 v[100:101], v[100:101], s[44:45]
    v_pk_mul_f32 v[102:103], v[102:103], s[44:45]
    v_cvt_pk_bf16_f32 v148, v96, v97
    v_cvt_pk_bf16_f32 v149, v98, v99
    v_cvt_pk_bf16_f32 v150, v100, v101
    v_cvt_pk_bf16_f32 v151, v102, v103
    v_mfma_f32_16x16x32_bf16 v[164:167], a[24:27], v[144:147], v[164:167]
    v_fma_f32 v168, v168, s44, v208
    v_fma_f32 v169, v169, s44, v208
    v_mfma_f32_16x16x32_bf16 v[160:163], a[12:15], v[148:151], v[160:163]
    v_exp_f32 v168, v168
    v_mfma_f32_16x16x32_bf16 v[164:167], a[28:31], v[148:151], v[164:167]
    v_exp_f32 v169, v169
    v_mfma_f32_16x16x32_bf16 v[40:43], a[64:67], v[240:243], 0
    v_fma_f32 v170, v170, s44, v208
    v_fma_f32 v171, v171, s44, v208
    v_mfma_f32_16x16x32_bf16 v[44:47], a[68:71], v[240:243], 0
    v_exp_f32 v170, v170
    v_mfma_f32_16x16x32_bf16 v[48:51], a[72:75], v[240:243], 0
    v_exp_f32 v171, v171
    v_mfma_f32_16x16x32_bf16 v[52:55], a[76:79], v[240:243], 0
    v_fma_f32 v172, v172, s44, v208
    v_fma_f32 v173, v173, s44, v208
    v_mfma_f32_16x16x32_bf16 v[56:59], a[80:83], v[240:243], 0
    v_exp_f32 v172, v172
    v_mfma_f32_16x16x32_bf16 v[60:63], a[84:87], v[240:243], 0
    v_exp_f32 v173, v173
    v_mfma_f32_16x16x32_bf16 v[64:67], a[88:91], v[240:243], 0
    v_fma_f32 v174, v174, s44, v208
    v_fma_f32 v175, v175, s44, v208
    v_mfma_f32_16x16x32_bf16 v[68:71], a[92:95], v[240:243], 0
    v_exp_f32 v174, v174
    v_mfma_f32_16x16x32_bf16 a[136:139], a[128:131], v[240:243], 0
    v_exp_f32 v175, v175
    v_cvt_pk_bf16_f32 v248, v168, v169
    v_cvt_pk_bf16_f32 v249, v170, v171
    v_mfma_f32_16x16x32_bf16 v[168:171], a[32:35], v[136:139], v[208:211]
    v_cvt_pk_bf16_f32 v250, v172, v173
    v_cvt_pk_bf16_f32 v251, v174, v175
    v_mfma_f32_16x16x32_bf16 v[172:175], a[48:51], v[136:139], v[208:211]
    v_fma_f32 v152, v152, s44, v208
    v_fma_f32 v153, v153, s44, v208
    v_mfma_f32_16x16x32_bf16 v[168:171], a[36:39], v[140:143], v[168:171]
    v_exp_f32 v152, v152
    v_mfma_f32_16x16x32_bf16 v[172:175], a[52:55], v[140:143], v[172:175]
    v_exp_f32 v153, v153
    v_mfma_f32_16x16x32_bf16 v[168:171], a[40:43], v[144:147], v[168:171]
    v_fma_f32 v154, v154, s44, v208
    v_fma_f32 v155, v155, s44, v208
    v_mfma_f32_16x16x32_bf16 v[172:175], a[56:59], v[144:147], v[172:175]
    v_exp_f32 v154, v154
    v_mfma_f32_16x16x32_bf16 v[168:171], a[44:47], v[148:151], v[168:171]
    v_exp_f32 v155, v155
    v_mfma_f32_16x16x32_bf16 v[172:175], a[60:63], v[148:151], v[172:175]
    v_fma_f32 v156, v156, s44, v208
    v_fma_f32 v157, v157, s44, v208
    v_mfma_f32_16x16x32_bf16 v[40:43], a[96:99], v[244:247], v[40:43]
    v_exp_f32 v156, v156
    v_mfma_f32_16x16x32_bf16 v[44:47], a[100:103], v[244:247], v[44:47]
    v_exp_f32 v157, v157
    v_mfma_f32_16x16x32_bf16 v[48:51], a[104:107], v[244:247], v[48:51]
    v_fma_f32 v158, v158, s44, v208
    v_fma_f32 v159, v159, s44, v208
    v_mfma_f32_16x16x32_bf16 v[52:55], a[108:111], v[244:247], v[52:55]
    v_exp_f32 v158, v158
    v_mfma_f32_16x16x32_bf16 v[56:59], a[112:115], v[244:247], v[56:59]
    v_exp_f32 v159, v159
    v_mfma_f32_16x16x32_bf16 v[60:63], a[116:119], v[244:247], v[60:63]
    v_cvt_pk_bf16_f32 v252, v152, v153
    v_cvt_pk_bf16_f32 v253, v154, v155
    v_mfma_f32_16x16x32_bf16 v[64:67], a[120:123], v[244:247], v[64:67]
    v_cvt_pk_bf16_f32 v254, v156, v157
    v_cvt_pk_bf16_f32 v255, v158, v159
    v_mfma_f32_16x16x32_bf16 v[68:71], a[124:127], v[244:247], v[68:71]
    v_exp_f32 v160, v160
    v_mfma_f32_16x16x32_bf16 a[136:139], a[128:131], v[244:247], a[136:139]
    v_exp_f32 v161, v161
    v_mfma_f32_16x16x32_bf16 v[72:75], a[64:67], v[248:251], 0
    v_exp_f32 v162, v162
    v_mfma_f32_16x16x32_bf16 v[76:79], a[68:71], v[248:251], 0
    v_exp_f32 v163, v163
    v_mfma_f32_16x16x32_bf16 v[80:83], a[72:75], v[248:251], 0
    v_exp_f32 v164, v164
    v_mfma_f32_16x16x32_bf16 v[84:87], a[76:79], v[248:251], 0
    v_exp_f32 v165, v165
    v_mfma_f32_16x16x32_bf16 v[88:91], a[80:83], v[248:251], 0
    v_exp_f32 v166, v166
    v_mfma_f32_16x16x32_bf16 v[92:95], a[84:87], v[248:251], 0
    v_exp_f32 v167, v167
    v_mfma_f32_16x16x32_bf16 v[96:99], a[88:91], v[248:251], 0
    v_cvt_pk_bf16_f32 v184, v160, v161
    v_cvt_pk_bf16_f32 v185, v162, v163
    v_mfma_f32_16x16x32_bf16 v[100:103], a[92:95], v[248:251], 0
    v_cvt_pk_bf16_f32 v186, v164, v165
    v_cvt_pk_bf16_f32 v187, v166, v167
    v_mfma_f32_16x16x32_bf16 a[140:143], a[128:131], v[248:251], 0
    s_waitcnt vmcnt(4)
    s_barrier
    s_add_u32 s34, s32, 32768
    s_add_u32 m0, s33, 114688
    s_nop 0
    buffer_load_dwordx4 v224, s[12:15], s34 offen offset:0  lds
    buffer_load_dwordx4 v225, s[12:15], s34 offen offset:1024  lds
    buffer_load_dwordx4 v224, s[12:15], s34 offen offset:2048  lds
    buffer_load_dwordx4 v225, s[12:15], s34 offen offset:3072  lds
    v_add_u32 v212, 16384, v212
    ds_read_b128 a[0:3], v212 offset:0
    v_mfma_f32_16x16x32_bf16 v[72:75], a[96:99], v[252:255], v[72:75]
    ds_read_b128 a[16:19], v212 offset:4096
    v_add_u32 v213, 16384, v213
    v_mfma_f32_16x16x32_bf16 v[76:79], a[100:103], v[252:255], v[76:79]
    ds_read_b128 a[4:7], v213 offset:0
    ds_read_b128 a[20:23], v213 offset:4096
    v_mfma_f32_16x16x32_bf16 v[80:83], a[104:107], v[252:255], v[80:83]
    v_add_u32 v214, 16384, v214
    ds_read_b128 a[8:11], v214 offset:0
    v_mfma_f32_16x16x32_bf16 v[84:87], a[108:111], v[252:255], v[84:87]
    ds_read_b128 a[24:27], v214 offset:4096
    v_add_u32 v215, 16384, v215
    v_mfma_f32_16x16x32_bf16 v[88:91], a[112:115], v[252:255], v[88:91]
    ds_read_b128 a[12:15], v215 offset:0
    v_add_u32 v216, 16384, v216
    v_mfma_f32_16x16x32_bf16 v[92:95], a[116:119], v[252:255], v[92:95]
    ds_read_b128 a[28:31], v215 offset:4096
    v_add_u32 v217, 16384, v217
    v_mfma_f32_16x16x32_bf16 v[96:99], a[120:123], v[252:255], v[96:99]
    ds_read_b64_tr_b16 a[64:65], v216 offset:0
    ds_read_b64_tr_b16 a[66:67], v216 offset:4096
    v_mfma_f32_16x16x32_bf16 v[100:103], a[124:127], v[252:255], v[100:103]
    ds_read_b64_tr_b16 a[68:69], v217 offset:0
    ds_read_b64_tr_b16 a[70:71], v217 offset:4096
    v_mfma_f32_16x16x32_bf16 a[140:143], a[128:131], v[252:255], a[140:143]
    v_add_u32 v218, 16384, v218
    ds_read_b64_tr_b16 a[72:73], v218 offset:0
    ds_read_b64_tr_b16 a[74:75], v218 offset:4096
    v_add_u32 v219, 16384, v219
    ds_read_b64_tr_b16 a[76:77], v219 offset:0
    ds_read_b64_tr_b16 a[78:79], v219 offset:4096
    v_add_u32 v220, 16384, v220
    ds_read_b64_tr_b16 a[80:81], v220 offset:0
    ds_read_b64_tr_b16 a[82:83], v220 offset:4096
    v_add_u32 v221, 16384, v221
    ds_read_b64_tr_b16 a[84:85], v221 offset:0
    ds_read_b64_tr_b16 a[86:87], v221 offset:4096
    v_add_u32 v222, 16384, v222
    ds_read_b64_tr_b16 a[88:89], v222 offset:0
    ds_read_b64_tr_b16 a[90:91], v222 offset:4096
    v_add_u32 v223, 16384, v223
    ds_read_b64_tr_b16 a[92:93], v223 offset:0
    ds_read_b64_tr_b16 a[94:95], v223 offset:4096
    v_lshlrev_b32 v164, 16, v194
    v_and_b32 v165, 0xffff0000, v194
    v_lshlrev_b32 v166, 16, v195
    v_and_b32 v167, 0xffff0000, v195
    s_add_u32 s34, s32, 65536
    s_add_u32 m0, s33, 65536
    s_nop 0
    buffer_load_dwordx4 v224, s[8:11], s34 offen offset:0  lds
    buffer_load_dwordx4 v225, s[8:11], s34 offen offset:1024  lds
    buffer_load_dwordx4 v224, s[8:11], s34 offen offset:2048  lds
    buffer_load_dwordx4 v225, s[8:11], s34 offen offset:3072  lds
    s_waitcnt lgkmcnt(0)
L_loop:
    v_mfma_f32_16x16x32_bf16 v[152:155], a[0:3], v[104:107], v[200:203]
    ds_read_b128 a[32:35], v212 offset:8192
    v_cvt_pk_bf16_f32 v194, v164, v165
    v_mfma_f32_16x16x32_bf16 v[8:11], a[64:67], v[176:179], v[8:11]
    s_cmp_eq_u32 s36, 4
    s_cselect_b32 s41, s46, s43
    v_exp_f32 v168, v168
    v_mfma_f32_16x16x32_bf16 v[156:159], a[16:19], v[104:107], v[200:203]
    ds_read_b64_tr_b16 a[96:97], v216 offset:8192
    v_cvt_pk_bf16_f32 v195, v166, v167
    v_mfma_f32_16x16x32_bf16 v[12:15], a[68:71], v[176:179], v[12:15]
    s_cmp_eq_u32 s36, 5
    s_cselect_b32 s42, s46, s43
    v_exp_f32 v169, v169
    v_mfma_f32_16x16x32_bf16 v[152:155], a[4:7], v[108:111], v[152:155]
    ds_read_b64_tr_b16 a[98:99], v216 offset:12288
    ds_read_b64_tr_b16 a[100:101], v217 offset:8192
    v_mfma_f32_16x16x32_bf16 v[16:19], a[72:75], v[176:179], v[16:19]
    v_exp_f32 v170, v170
    v_mfma_f32_16x16x32_bf16 v[156:159], a[20:23], v[108:111], v[156:159]
    ds_read_b128 a[48:51], v212 offset:12288
    v_cvt_pk_bf16_f32 v196, v168, v169
    v_mfma_f32_16x16x32_bf16 v[20:23], a[76:79], v[176:179], v[20:23]
    v_exp_f32 v171, v171
    v_mfma_f32_16x16x32_bf16 v[152:155], a[8:11], v[112:115], v[152:155]
    ds_read_b64_tr_b16 a[102:103], v217 offset:12288
    ds_read_b64_tr_b16 a[104:105], v218 offset:8192
    v_mfma_f32_16x16x32_bf16 v[24:27], a[80:83], v[176:179], v[24:27]
    v_exp_f32 v172, v172
    v_mfma_f32_16x16x32_bf16 v[156:159], a[24:27], v[112:115], v[156:159]
    ds_read_b128 a[36:39], v213 offset:8192
    v_cvt_pk_bf16_f32 v197, v170, v171
    v_mfma_f32_16x16x32_bf16 v[28:31], a[84:87], v[176:179], v[28:31]
    v_exp_f32 v173, v173
    v_mfma_f32_16x16x32_bf16 v[152:155], a[12:15], v[116:119], v[152:155]
    ds_read_b64_tr_b16 a[106:107], v218 offset:12288
    v_mfma_f32_16x16x32_bf16 v[32:35], a[88:91], v[176:179], v[32:35]
    s_mov_b32 m0, s40
    v_exp_f32 v174, v174
    v_mfma_f32_16x16x32_bf16 v[156:159], a[28:31], v[116:119], v[156:159]
    buffer_load_dwordx4 v224, s[12:15], s38 offen offset:0  lds
    v_mfma_f32_16x16x32_bf16 v[36:39], a[92:95], v[176:179], v[36:39]
    v_exp_f32 v175, v175
    v_mfma_f32_16x16x32_bf16 a[132:135], a[128:131], v[176:179], a[132:135]
    buffer_load_dwordx4 v225, s[12:15], s38 offen offset:1024  lds
    v_mfma_f32_16x16x32_bf16 v[160:163], a[0:3], v[120:123], v[204:207]
    ds_read_b128 a[52:55], v213 offset:12288
    v_cvt_pk_bf16_f32 v198, v172, v173
    v_mfma_f32_16x16x32_bf16 v[40:43], a[64:67], v[180:183], v[40:43]
    v_exp_f32 v152, v152
    v_mfma_f32_16x16x32_bf16 v[164:167], a[16:19], v[120:123], v[204:207]
    ds_read_b64_tr_b16 a[108:109], v219 offset:8192
    v_cvt_pk_bf16_f32 v199, v174, v175
    v_mfma_f32_16x16x32_bf16 v[44:47], a[68:71], v[180:183], v[44:47]
    v_exp_f32 v153, v153
    v_mfma_f32_16x16x32_bf16 v[160:163], a[4:7], v[124:127], v[160:163]
    ds_read_b64_tr_b16 a[110:111], v219 offset:12288
    ds_read_b64_tr_b16 a[112:113], v220 offset:8192
    v_mfma_f32_16x16x32_bf16 v[48:51], a[72:75], v[180:183], v[48:51]
    v_exp_f32 v154, v154
    v_mfma_f32_16x16x32_bf16 v[164:167], a[20:23], v[124:127], v[164:167]
    ds_read_b128 a[40:43], v214 offset:8192
    v_cvt_pk_bf16_f32 v176, v152, v153
    v_mfma_f32_16x16x32_bf16 v[52:55], a[76:79], v[180:183], v[52:55]
    v_exp_f32 v155, v155
    v_mfma_f32_16x16x32_bf16 v[160:163], a[8:11], v[128:131], v[160:163]
    ds_read_b64_tr_b16 a[114:115], v220 offset:12288
    ds_read_b64_tr_b16 a[116:117], v221 offset:8192
    v_mfma_f32_16x16x32_bf16 v[56:59], a[80:83], v[180:183], v[56:59]
    v_exp_f32 v156, v156
    v_mfma_f32_16x16x32_bf16 v[164:167], a[24:27], v[128:131], v[164:167]
    ds_read_b128 a[56:59], v214 offset:12288
    v_cvt_pk_bf16_f32 v177, v154, v155
    v_mfma_f32_16x16x32_bf16 v[60:63], a[84:87], v[180:183], v[60:63]
    v_exp_f32 v157, v157
    v_mfma_f32_16x16x32_bf16 v[160:163], a[12:15], v[132:135], v[160:163]
    ds_read_b64_tr_b16 a[118:119], v221 offset:12288
    v_add_u32 v216, s42, v216
    v_mfma_f32_16x16x32_bf16 v[64:67], a[88:91], v[180:183], v[64:67]
    v_exp_f32 v158, v158
    v_mfma_f32_16x16x32_bf16 v[164:167], a[28:31], v[132:135], v[164:167]
    buffer_load_dwordx4 v224, s[12:15], s38 offen offset:2048  lds
    v_mfma_f32_16x16x32_bf16 v[68:71], a[92:95], v[180:183], v[68:71]
    v_exp_f32 v159, v159
    v_mfma_f32_16x16x32_bf16 a[136:139], a[128:131], v[180:183], a[136:139]
    buffer_load_dwordx4 v225, s[12:15], s38 offen offset:3072  lds
    v_mfma_f32_16x16x32_bf16 v[168:171], a[0:3], v[136:139], v[208:211]
    ds_read_b128 a[44:47], v215 offset:8192
    v_cvt_pk_bf16_f32 v178, v156, v157
    v_mfma_f32_16x16x32_bf16 v[72:75], a[64:67], v[184:187], v[72:75]
    s_add_u32 s38, s38, 16384
    s_add_u32 s40, s40, 16384
    v_exp_f32 v160, v160
    v_mfma_f32_16x16x32_bf16 v[172:175], a[16:19], v[136:139], v[208:211]
    ds_read_b64_tr_b16 a[120:121], v222 offset:8192
    v_cvt_pk_bf16_f32 v179, v158, v159
    v_mfma_f32_16x16x32_bf16 v[76:79], a[68:71], v[184:187], v[76:79]
    s_cmp_eq_u32 s36, 3
    s_cselect_b32 s34, 81920, 0
    v_exp_f32 v161, v161
    v_mfma_f32_16x16x32_bf16 v[168:171], a[4:7], v[140:143], v[168:171]
    ds_read_b64_tr_b16 a[122:123], v222 offset:12288
    ds_read_b64_tr_b16 a[124:125], v223 offset:8192
    v_mfma_f32_16x16x32_bf16 v[80:83], a[72:75], v[184:187], v[80:83]
    s_sub_u32 s40, s40, s34
    s_cmp_ge_u32 s36, 6
    v_exp_f32 v162, v162
    v_mfma_f32_16x16x32_bf16 v[172:175], a[20:23], v[140:143], v[172:175]
    ds_read_b128 a[60:63], v215 offset:12288
    v_cvt_pk_bf16_f32 v180, v160, v161
    v_mfma_f32_16x16x32_bf16 v[84:87], a[76:79], v[184:187], v[84:87]
    s_cselect_b32 s40, s47, s40
    s_cselect_b32 s14, 0, s14
    v_exp_f32 v163, v163
    v_mfma_f32_16x16x32_bf16 v[168:171], a[8:11], v[144:147], v[168:171]
    ds_read_b64_tr_b16 a[126:127], v223 offset:12288
    v_add_u32 v217, s42, v217
    v_mfma_f32_16x16x32_bf16 v[88:91], a[80:83], v[184:187], v[88:91]
    v_exp_f32 v164, v164
    v_mfma_f32_16x16x32_bf16 v[172:175], a[24:27], v[144:147], v[172:175]
    v_cvt_pk_bf16_f32 v181, v162, v163
    v_add_u32 v218, s42, v218
    v_mfma_f32_16x16x32_bf16 v[92:95], a[84:87], v[184:187], v[92:95]
    v_exp_f32 v165, v165
    v_mfma_f32_16x16x32_bf16 v[168:171], a[12:15], v[148:151], v[168:171]
    v_add_u32 v219, s42, v219
    v_add_u32 v220, s42, v220
    v_mfma_f32_16x16x32_bf16 v[96:99], a[88:91], v[184:187], v[96:99]
    v_exp_f32 v166, v166
    v_mfma_f32_16x16x32_bf16 v[172:175], a[28:31], v[148:151], v[172:175]
    v_add_u32 v221, s42, v221
    v_add_u32 v212, s41, v212
    v_mfma_f32_16x16x32_bf16 v[100:103], a[92:95], v[184:187], v[100:103]
    v_exp_f32 v167, v167
    v_mfma_f32_16x16x32_bf16 a[140:143], a[128:131], v[184:187], a[140:143]
    s_waitcnt vmcnt(8) lgkmcnt(0)
    s_barrier
    v_add_u32 v214, s41, v214
    v_add_u32 v215, s41, v215
    v_mfma_f32_16x16x32_bf16 v[152:155], a[32:35], v[104:107], v[200:203]
    v_cvt_pk_bf16_f32 v182, v164, v165
    v_add_u32 v222, s42, v222
    v_mfma_f32_16x16x32_bf16 v[8:11], a[96:99], v[188:191], v[8:11]
    v_exp_f32 v168, v168
    v_mfma_f32_16x16x32_bf16 v[156:159], a[48:51], v[104:107], v[200:203]
    v_cvt_pk_bf16_f32 v183, v166, v167
    v_add_u32 v213, s41, v213
    v_mfma_f32_16x16x32_bf16 v[12:15], a[100:103], v[188:191], v[12:15]
    v_exp_f32 v169, v169
    v_mfma_f32_16x16x32_bf16 v[152:155], a[36:39], v[108:111], v[152:155]
    ds_read_b64_tr_b16 a[64:65], v216 offset:0
    ds_read_b64_tr_b16 a[66:67], v216 offset:4096
    v_mfma_f32_16x16x32_bf16 v[16:19], a[104:107], v[188:191], v[16:19]
    v_exp_f32 v170, v170
    v_mfma_f32_16x16x32_bf16 v[156:159], a[52:55], v[108:111], v[156:159]
    ds_read_b128 a[0:3], v212 offset:0
    v_cvt_pk_bf16_f32 v184, v168, v169
    v_mfma_f32_16x16x32_bf16 v[20:23], a[108:111], v[188:191], v[20:23]
    v_exp_f32 v171, v171
    v_mfma_f32_16x16x32_bf16 v[152:155], a[40:43], v[112:115], v[152:155]
    ds_read_b64_tr_b16 a[68:69], v217 offset:0
    ds_read_b64_tr_b16 a[70:71], v217 offset:4096
    v_mfma_f32_16x16x32_bf16 v[24:27], a[112:115], v[188:191], v[24:27]
    v_exp_f32 v172, v172
    v_mfma_f32_16x16x32_bf16 v[156:159], a[56:59], v[112:115], v[156:159]
    ds_read_b128 a[16:19], v212 offset:4096
    v_cvt_pk_bf16_f32 v185, v170, v171
    v_mfma_f32_16x16x32_bf16 v[28:31], a[116:119], v[188:191], v[28:31]
    v_exp_f32 v173, v173
    v_mfma_f32_16x16x32_bf16 v[152:155], a[44:47], v[116:119], v[152:155]
    ds_read_b128 a[4:7], v213 offset:0
    ds_read_b64_tr_b16 a[72:73], v218 offset:0
    v_mfma_f32_16x16x32_bf16 v[32:35], a[120:123], v[188:191], v[32:35]
    s_mov_b32 m0, s39
    v_exp_f32 v174, v174
    v_mfma_f32_16x16x32_bf16 v[156:159], a[60:63], v[116:119], v[156:159]
    buffer_load_dwordx4 v224, s[8:11], s37 offen offset:0  lds
    v_mfma_f32_16x16x32_bf16 v[36:39], a[124:127], v[188:191], v[36:39]
    v_exp_f32 v175, v175
    v_mfma_f32_16x16x32_bf16 a[132:135], a[128:131], v[188:191], a[132:135]
    buffer_load_dwordx4 v225, s[8:11], s37 offen offset:1024  lds
    v_mfma_f32_16x16x32_bf16 v[160:163], a[32:35], v[120:123], v[204:207]
    ds_read_b128 a[20:23], v213 offset:4096
    v_cvt_pk_bf16_f32 v186, v172, v173
    v_mfma_f32_16x16x32_bf16 v[40:43], a[96:99], v[192:195], v[40:43]
    v_exp_f32 v152, v152
    v_mfma_f32_16x16x32_bf16 v[164:167], a[48:51], v[120:123], v[204:207]
    ds_read_b64_tr_b16 a[74:75], v218 offset:4096
    v_cvt_pk_bf16_f32 v187, v174, v175
    v_mfma_f32_16x16x32_bf16 v[44:47], a[100:103], v[192:195], v[44:47]
    v_exp_f32 v153, v153
    v_mfma_f32_16x16x32_bf16 v[160:163], a[36:39], v[124:127], v[160:163]
    ds_read_b64_tr_b16 a[76:77], v219 offset:0
    ds_read_b64_tr_b16 a[78:79], v219 offset:4096
    v_mfma_f32_16x16x32_bf16 v[48:51], a[104:107], v[192:195], v[48:51]
    v_exp_f32 v154, v154
    v_mfma_f32_16x16x32_bf16 v[164:167], a[52:55], v[124:127], v[164:167]
    ds_read_b128 a[8:11], v214 offset:0
    v_cvt_pk_bf16_f32 v188, v152, v153
    v_mfma_f32_16x16x32_bf16 v[52:55], a[108:111], v[192:195], v[52:55]
    v_exp_f32 v155, v155
    v_mfma_f32_16x16x32_bf16 v[160:163], a[40:43], v[128:131], v[160:163]
    ds_read_b64_tr_b16 a[80:81], v220 offset:0
    ds_read_b64_tr_b16 a[82:83], v220 offset:4096
    v_mfma_f32_16x16x32_bf16 v[56:59], a[112:115], v[192:195], v[56:59]
    v_exp_f32 v156, v156
    v_mfma_f32_16x16x32_bf16 v[164:167], a[56:59], v[128:131], v[164:167]
    ds_read_b128 a[24:27], v214 offset:4096
    v_cvt_pk_bf16_f32 v189, v154, v155
    v_mfma_f32_16x16x32_bf16 v[60:63], a[116:119], v[192:195], v[60:63]
    v_exp_f32 v157, v157
    v_mfma_f32_16x16x32_bf16 v[160:163], a[44:47], v[132:135], v[160:163]
    ds_read_b64_tr_b16 a[84:85], v221 offset:0
    v_add_u32 v223, s42, v223
    v_mfma_f32_16x16x32_bf16 v[64:67], a[120:123], v[192:195], v[64:67]
    v_exp_f32 v158, v158
    v_mfma_f32_16x16x32_bf16 v[164:167], a[60:63], v[132:135], v[164:167]
    buffer_load_dwordx4 v224, s[8:11], s37 offen offset:2048  lds
    v_mfma_f32_16x16x32_bf16 v[68:71], a[124:127], v[192:195], v[68:71]
    v_exp_f32 v159, v159
    v_mfma_f32_16x16x32_bf16 a[136:139], a[128:131], v[192:195], a[136:139]
    buffer_load_dwordx4 v225, s[8:11], s37 offen offset:3072  lds
    v_mfma_f32_16x16x32_bf16 v[168:171], a[32:35], v[136:139], v[208:211]
    ds_read_b128 a[12:15], v215 offset:0
    v_cvt_pk_bf16_f32 v190, v156, v157
    v_mfma_f32_16x16x32_bf16 v[72:75], a[96:99], v[196:199], v[72:75]
    s_add_u32 s37, s37, 16384
    s_add_u32 s39, s39, 16384
    v_exp_f32 v160, v160
    v_mfma_f32_16x16x32_bf16 v[172:175], a[48:51], v[136:139], v[208:211]
    ds_read_b64_tr_b16 a[86:87], v221 offset:4096
    v_cvt_pk_bf16_f32 v191, v158, v159
    v_mfma_f32_16x16x32_bf16 v[76:79], a[100:103], v[196:199], v[76:79]
    s_cmp_eq_u32 s36, 1
    s_cselect_b32 s34, 81920, 0
    v_exp_f32 v161, v161
    v_mfma_f32_16x16x32_bf16 v[168:171], a[36:39], v[140:143], v[168:171]
    ds_read_b64_tr_b16 a[88:89], v222 offset:0
    ds_read_b64_tr_b16 a[90:91], v222 offset:4096
    v_mfma_f32_16x16x32_bf16 v[80:83], a[104:107], v[196:199], v[80:83]
    s_sub_u32 s39, s39, s34
    s_cmp_ge_u32 s36, 4
    v_exp_f32 v162, v162
    v_mfma_f32_16x16x32_bf16 v[172:175], a[52:55], v[140:143], v[172:175]
    ds_read_b128 a[28:31], v215 offset:4096
    v_cvt_pk_bf16_f32 v192, v160, v161
    v_mfma_f32_16x16x32_bf16 v[84:87], a[108:111], v[196:199], v[84:87]
    s_cselect_b32 s39, s47, s39
    s_cselect_b32 s10, 0, s10
    v_exp_f32 v163, v163
    v_mfma_f32_16x16x32_bf16 v[168:171], a[40:43], v[144:147], v[168:171]
    ds_read_b64_tr_b16 a[92:93], v223 offset:0
    ds_read_b64_tr_b16 a[94:95], v223 offset:4096
    v_mfma_f32_16x16x32_bf16 v[88:91], a[112:115], v[196:199], v[88:91]
    s_add_u32 s36, s36, 1
    v_exp_f32 v164, v164
    v_mfma_f32_16x16x32_bf16 v[172:175], a[56:59], v[144:147], v[172:175]
    v_cvt_pk_bf16_f32 v193, v162, v163
    v_mfma_f32_16x16x32_bf16 v[92:95], a[116:119], v[196:199], v[92:95]
    v_exp_f32 v165, v165
    v_mfma_f32_16x16x32_bf16 v[168:171], a[44:47], v[148:151], v[168:171]
    v_mfma_f32_16x16x32_bf16 v[96:99], a[120:123], v[196:199], v[96:99]
    v_exp_f32 v166, v166
    v_mfma_f32_16x16x32_bf16 v[172:175], a[60:63], v[148:151], v[172:175]
    v_mfma_f32_16x16x32_bf16 v[100:103], a[124:127], v[196:199], v[100:103]
    v_exp_f32 v167, v167
    v_mfma_f32_16x16x32_bf16 a[140:143], a[128:131], v[196:199], a[140:143]
    s_waitcnt lgkmcnt(0)
    s_cmp_lt_u32 s36, 7
    s_cbranch_scc1 L_loop
    ds_read_b128 a[32:35], v212 offset:8192
    v_cvt_pk_bf16_f32 v194, v164, v165
    v_mfma_f32_16x16x32_bf16 v[152:155], a[0:3], v[104:107], v[200:203]
    ds_read_b128 a[48:51], v212 offset:12288
    v_cvt_pk_bf16_f32 v195, v166, v167
    v_mfma_f32_16x16x32_bf16 v[156:159], a[16:19], v[104:107], v[200:203]
    v_exp_f32 v168, v168
    v_mfma_f32_16x16x32_bf16 v[152:155], a[4:7], v[108:111], v[152:155]
    s_waitcnt vmcnt(0)
    s_barrier
    v_exp_f32 v169, v169
    v_mfma_f32_16x16x32_bf16 v[156:159], a[20:23], v[108:111], v[156:159]
    v_exp_f32 v170, v170
    v_mfma_f32_16x16x32_bf16 v[152:155], a[8:11], v[112:115], v[152:155]
    ds_read_b128 a[36:39], v213 offset:8192
    ds_read_b128 a[52:55], v213 offset:12288
    v_mfma_f32_16x16x32_bf16 v[156:159], a[24:27], v[112:115], v[156:159]
    ds_read_b128 a[40:43], v214 offset:8192
    v_cvt_pk_bf16_f32 v196, v168, v169
    v_mfma_f32_16x16x32_bf16 v[152:155], a[12:15], v[116:119], v[152:155]
    v_exp_f32 v171, v171
    v_mfma_f32_16x16x32_bf16 v[156:159], a[28:31], v[116:119], v[156:159]
    v_exp_f32 v172, v172
    v_mfma_f32_16x16x32_bf16 v[8:11], a[64:67], v[176:179], v[8:11]
    ds_read_b128 a[56:59], v214 offset:12288
    ds_read_b128 a[44:47], v215 offset:8192
    v_mfma_f32_16x16x32_bf16 v[12:15], a[68:71], v[176:179], v[12:15]
    ds_read_b128 a[60:63], v215 offset:12288
    v_cvt_pk_bf16_f32 v197, v170, v171
    v_mfma_f32_16x16x32_bf16 v[16:19], a[72:75], v[176:179], v[16:19]
    v_exp_f32 v173, v173
    v_mfma_f32_16x16x32_bf16 v[20:23], a[76:79], v[176:179], v[20:23]
    v_exp_f32 v174, v174
    v_mfma_f32_16x16x32_bf16 v[24:27], a[80:83], v[176:179], v[24:27]
    ds_read_b64_tr_b16 a[96:97], v216 offset:8192
    ds_read_b64_tr_b16 a[98:99], v216 offset:12288
    v_mfma_f32_16x16x32_bf16 v[28:31], a[84:87], v[176:179], v[28:31]
    ds_read_b64_tr_b16 a[100:101], v217 offset:8192
    ds_read_b64_tr_b16 a[102:103], v217 offset:12288
    v_mfma_f32_16x16x32_bf16 v[32:35], a[88:91], v[176:179], v[32:35]
    ds_read_b64_tr_b16 a[104:105], v218 offset:8192
    ds_read_b64_tr_b16 a[106:107], v218 offset:12288
    v_mfma_f32_16x16x32_bf16 v[36:39], a[92:95], v[176:179], v[36:39]
    ds_read_b64_tr_b16 a[108:109], v219 offset:8192
    ds_read_b64_tr_b16 a[110:111], v219 offset:12288
    v_mfma_f32_16x16x32_bf16 a[132:135], a[128:131], v[176:179], a[132:135]
    s_waitcnt lgkmcnt(8)
    ds_read_b64_tr_b16 a[112:113], v220 offset:8192
    ds_read_b64_tr_b16 a[114:115], v220 offset:12288
    v_mfma_f32_16x16x32_bf16 v[160:163], a[32:35], v[104:107], v[200:203]
    ds_read_b64_tr_b16 a[116:117], v221 offset:8192
    ds_read_b64_tr_b16 a[118:119], v221 offset:12288
    v_mfma_f32_16x16x32_bf16 v[164:167], a[48:51], v[104:107], v[200:203]
    ds_read_b64_tr_b16 a[120:121], v222 offset:8192
    ds_read_b64_tr_b16 a[122:123], v222 offset:12288
    v_mfma_f32_16x16x32_bf16 v[160:163], a[36:39], v[108:111], v[160:163]
    ds_read_b64_tr_b16 a[124:125], v223 offset:8192
    ds_read_b64_tr_b16 a[126:127], v223 offset:12288
    v_mfma_f32_16x16x32_bf16 v[164:167], a[52:55], v[108:111], v[164:167]
    v_exp_f32 v175, v175
    v_mfma_f32_16x16x32_bf16 v[160:163], a[40:43], v[112:115], v[160:163]
    v_cvt_pk_bf16_f32 v198, v172, v173
    v_add_u32 v216, 16384, v216
    v_mfma_f32_16x16x32_bf16 v[164:167], a[56:59], v[112:115], v[164:167]
    v_cvt_pk_bf16_f32 v199, v174, v175
    v_add_u32 v217, 16384, v217
    v_mfma_f32_16x16x32_bf16 v[160:163], a[44:47], v[116:119], v[160:163]
    v_exp_f32 v152, v152
    v_mfma_f32_16x16x32_bf16 v[164:167], a[60:63], v[116:119], v[164:167]
    s_waitcnt lgkmcnt(0)
    v_exp_f32 v153, v153
    v_mfma_f32_16x16x32_bf16 v[8:11], a[96:99], v[188:191], v[8:11]
    v_exp_f32 v154, v154
    v_mfma_f32_16x16x32_bf16 v[12:15], a[100:103], v[188:191], v[12:15]
    v_exp_f32 v155, v155
    v_mfma_f32_16x16x32_bf16 v[16:19], a[104:107], v[188:191], v[16:19]
    v_exp_f32 v156, v156
    v_mfma_f32_16x16x32_bf16 v[20:23], a[108:111], v[188:191], v[20:23]
    v_exp_f32 v157, v157
    v_mfma_f32_16x16x32_bf16 v[24:27], a[112:115], v[188:191], v[24:27]
    v_exp_f32 v158, v158
    v_mfma_f32_16x16x32_bf16 v[28:31], a[116:119], v[188:191], v[28:31]
    v_exp_f32 v159, v159
    v_mfma_f32_16x16x32_bf16 v[32:35], a[120:123], v[188:191], v[32:35]
    v_cvt_pk_bf16_f32 v176, v152, v153
    v_cvt_pk_bf16_f32 v177, v154, v155
    v_mfma_f32_16x16x32_bf16 v[36:39], a[124:127], v[188:191], v[36:39]
    v_cvt_pk_bf16_f32 v178, v156, v157
    v_cvt_pk_bf16_f32 v179, v158, v159
    v_mfma_f32_16x16x32_bf16 a[132:135], a[128:131], v[188:191], a[132:135]
    v_add_u32 v218, 16384, v218
    v_add_u32 v219, 16384, v219
    v_mfma_f32_16x16x32_bf16 v[168:171], a[0:3], v[120:123], v[204:207]
    v_add_u32 v220, 16384, v220
    v_add_u32 v221, 16384, v221
    v_mfma_f32_16x16x32_bf16 v[172:175], a[16:19], v[120:123], v[204:207]
    v_add_u32 v222, 16384, v222
    v_add_u32 v223, 16384, v223
    v_mfma_f32_16x16x32_bf16 v[168:171], a[4:7], v[124:127], v[168:171]
    v_exp_f32 v160, v160
    v_mfma_f32_16x16x32_bf16 v[172:175], a[20:23], v[124:127], v[172:175]
    v_exp_f32 v161, v161
    v_mfma_f32_16x16x32_bf16 v[168:171], a[8:11], v[128:131], v[168:171]
    v_exp_f32 v162, v162
    v_mfma_f32_16x16x32_bf16 v[172:175], a[24:27], v[128:131], v[172:175]
    ds_read_b64_tr_b16 a[144:145], v216 offset:0
    ds_read_b64_tr_b16 a[146:147], v216 offset:4096
    v_mfma_f32_16x16x32_bf16 v[168:171], a[12:15], v[132:135], v[168:171]
    ds_read_b64_tr_b16 a[148:149], v217 offset:0
    ds_read_b64_tr_b16 a[150:151], v217 offset:4096
    v_mfma_f32_16x16x32_bf16 v[172:175], a[28:31], v[132:135], v[172:175]
    ds_read_b64_tr_b16 a[152:153], v218 offset:0
    ds_read_b64_tr_b16 a[154:155], v218 offset:4096
    v_mfma_f32_16x16x32_bf16 v[40:43], a[64:67], v[180:183], v[40:43]
    ds_read_b64_tr_b16 a[156:157], v219 offset:0
    ds_read_b64_tr_b16 a[158:159], v219 offset:4096
    v_mfma_f32_16x16x32_bf16 v[44:47], a[68:71], v[180:183], v[44:47]
    ds_read_b64_tr_b16 a[160:161], v220 offset:0
    ds_read_b64_tr_b16 a[162:163], v220 offset:4096
    v_mfma_f32_16x16x32_bf16 v[48:51], a[72:75], v[180:183], v[48:51]
    ds_read_b64_tr_b16 a[164:165], v221 offset:0
    ds_read_b64_tr_b16 a[166:167], v221 offset:4096
    v_mfma_f32_16x16x32_bf16 v[52:55], a[76:79], v[180:183], v[52:55]
    ds_read_b64_tr_b16 a[168:169], v222 offset:0
    ds_read_b64_tr_b16 a[170:171], v222 offset:4096
    v_mfma_f32_16x16x32_bf16 v[56:59], a[80:83], v[180:183], v[56:59]
    ds_read_b64_tr_b16 a[172:173], v223 offset:0
    ds_read_b64_tr_b16 a[174:175], v223 offset:4096
    v_mfma_f32_16x16x32_bf16 v[60:63], a[84:87], v[180:183], v[60:63]
    v_exp_f32 v163, v163
    v_mfma_f32_16x16x32_bf16 v[64:67], a[88:91], v[180:183], v[64:67]
    v_exp_f32 v164, v164
    v_mfma_f32_16x16x32_bf16 v[68:71], a[92:95], v[180:183], v[68:71]
    v_exp_f32 v165, v165
    v_mfma_f32_16x16x32_bf16 a[136:139], a[128:131], v[180:183], a[136:139]
    v_exp_f32 v166, v166
    v_mfma_f32_16x16x32_bf16 v[152:155], a[32:35], v[120:123], v[204:207]
    v_exp_f32 v167, v167
    v_mfma_f32_16x16x32_bf16 v[156:159], a[48:51], v[120:123], v[204:207]
    ds_read_b64_tr_b16 a[176:177], v216 offset:8192
    ds_read_b64_tr_b16 a[178:179], v216 offset:12288
    v_mfma_f32_16x16x32_bf16 v[152:155], a[36:39], v[124:127], v[152:155]
    ds_read_b64_tr_b16 a[180:181], v217 offset:8192
    ds_read_b64_tr_b16 a[182:183], v217 offset:12288
    v_mfma_f32_16x16x32_bf16 v[156:159], a[52:55], v[124:127], v[156:159]
    ds_read_b64_tr_b16 a[184:185], v218 offset:8192
    ds_read_b64_tr_b16 a[186:187], v218 offset:12288
    v_mfma_f32_16x16x32_bf16 v[152:155], a[40:43], v[128:131], v[152:155]
    ds_read_b64_tr_b16 a[188:189], v219 offset:8192
    ds_read_b64_tr_b16 a[190:191], v219 offset:12288
    v_mfma_f32_16x16x32_bf16 v[156:159], a[56:59], v[128:131], v[156:159]
    ds_read_b64_tr_b16 a[192:193], v220 offset:8192
    ds_read_b64_tr_b16 a[194:195], v220 offset:12288
    v_mfma_f32_16x16x32_bf16 v[152:155], a[44:47], v[132:135], v[152:155]
    ds_read_b64_tr_b16 a[196:197], v221 offset:8192
    ds_read_b64_tr_b16 a[198:199], v221 offset:12288
    ds_read_b64_tr_b16 a[200:201], v222 offset:8192
    ds_read_b64_tr_b16 a[202:203], v222 offset:12288
    ds_read_b64_tr_b16 a[204:205], v223 offset:8192
    ds_read_b64_tr_b16 a[206:207], v223 offset:12288
    v_mfma_f32_16x16x32_bf16 v[156:159], a[60:63], v[132:135], v[156:159]
    v_cvt_pk_bf16_f32 v188, v160, v161
    v_cvt_pk_bf16_f32 v189, v162, v163
    v_cvt_pk_bf16_f32 v190, v164, v165
    v_cvt_pk_bf16_f32 v191, v166, v167
    v_mfma_f32_16x16x32_bf16 a[132:135], a[128:131], v[176:179], a[132:135]
    v_exp_f32 v168, v168
    v_mfma_f32_16x16x32_bf16 a[132:135], a[128:131], v[188:191], a[132:135]
    s_waitcnt lgkmcnt(15)
    v_exp_f32 v169, v169
    v_mfma_f32_16x16x32_bf16 v[8:11], a[144:147], v[176:179], v[8:11]
    s_waitcnt lgkmcnt(0)
    v_exp_f32 v170, v170
    v_mfma_f32_16x16x32_bf16 v[8:11], a[176:179], v[188:191], v[8:11]
    v_exp_f32 v171, v171
    v_mfma_f32_16x16x32_bf16 v[12:15], a[148:151], v[176:179], v[12:15]
    v_exp_f32 v172, v172
    v_mfma_f32_16x16x32_bf16 v[12:15], a[180:183], v[188:191], v[12:15]
    v_accvgpr_read_b32 v228, a132
    v_cvt_pk_bf16_f32 v248, v168, v169
    v_mfma_f32_16x16x32_bf16 v[16:19], a[152:155], v[176:179], v[16:19]
    v_cmp_ngt_f32 s[48:49], s58, v228
    v_cvt_pk_bf16_f32 v249, v170, v171
    v_mfma_f32_16x16x32_bf16 v[16:19], a[184:187], v[188:191], v[16:19]
    v_rcp_f32 v228, v228
    v_mfma_f32_16x16x32_bf16 v[20:23], a[156:159], v[176:179], v[20:23]
    v_mul_f32 v8, v8, v228
    v_mul_f32 v9, v9, v228
    v_mfma_f32_16x16x32_bf16 v[20:23], a[188:191], v[188:191], v[20:23]
    v_mul_f32 v10, v10, v228
    v_mul_f32 v11, v11, v228
    v_mfma_f32_16x16x32_bf16 v[24:27], a[160:163], v[176:179], v[24:27]
    v_mul_f32 v12, v12, v228
    v_mul_f32 v13, v13, v228
    v_mfma_f32_16x16x32_bf16 v[24:27], a[192:195], v[188:191], v[24:27]
    v_mul_f32 v14, v14, v228
    v_mul_f32 v15, v15, v228
    v_cvt_pk_bf16_f32 v104, v8, v9
    v_cvt_pk_bf16_f32 v105, v10, v11
    v_cvt_pk_bf16_f32 v106, v12, v13
    v_cvt_pk_bf16_f32 v107, v14, v15
    v_mfma_f32_16x16x32_bf16 v[28:31], a[164:167], v[176:179], v[28:31]
    v_permlane16_swap_b32 v104, v106
    v_permlane16_swap_b32 v105, v107
    buffer_store_dwordx4 v[104:107], v227, s[16:19], s28 offen offset:0 sc1
    v_mfma_f32_16x16x32_bf16 v[28:31], a[196:199], v[188:191], v[28:31]
    v_mul_f32 v16, v16, v228
    v_mul_f32 v17, v17, v228
    v_mfma_f32_16x16x32_bf16 v[32:35], a[168:171], v[176:179], v[32:35]
    v_mul_f32 v18, v18, v228
    v_mul_f32 v19, v19, v228
    v_mfma_f32_16x16x32_bf16 v[32:35], a[200:203], v[188:191], v[32:35]
    v_mul_f32 v20, v20, v228
    v_mul_f32 v21, v21, v228
    v_mfma_f32_16x16x32_bf16 v[36:39], a[172:175], v[176:179], v[36:39]
    v_mul_f32 v22, v22, v228
    v_mul_f32 v23, v23, v228
    v_mfma_f32_16x16x32_bf16 v[36:39], a[204:207], v[188:191], v[36:39]
    v_cvt_pk_bf16_f32 v108, v16, v17
    v_cvt_pk_bf16_f32 v109, v18, v19
    v_mfma_f32_16x16x32_bf16 v[160:163], a[0:3], v[136:139], v[208:211]
    v_cvt_pk_bf16_f32 v110, v20, v21
    v_cvt_pk_bf16_f32 v111, v22, v23
    v_mfma_f32_16x16x32_bf16 v[164:167], a[16:19], v[136:139], v[208:211]
    v_permlane16_swap_b32 v108, v110
    v_permlane16_swap_b32 v109, v111
    v_mfma_f32_16x16x32_bf16 v[160:163], a[4:7], v[140:143], v[160:163]
    v_exp_f32 v173, v173
    v_mfma_f32_16x16x32_bf16 v[164:167], a[20:23], v[140:143], v[164:167]
    v_exp_f32 v174, v174
    v_mfma_f32_16x16x32_bf16 v[160:163], a[8:11], v[144:147], v[160:163]
    v_exp_f32 v175, v175
    v_mfma_f32_16x16x32_bf16 v[164:167], a[24:27], v[144:147], v[164:167]
    v_cvt_pk_bf16_f32 v250, v172, v173
    v_mul_f32 v24, v24, v228
    v_mfma_f32_16x16x32_bf16 v[160:163], a[12:15], v[148:151], v[160:163]
    v_cvt_pk_bf16_f32 v251, v174, v175
    v_mul_f32 v25, v25, v228
    v_mfma_f32_16x16x32_bf16 v[164:167], a[28:31], v[148:151], v[164:167]
    buffer_store_dwordx4 v[108:111], v227, s[16:19], s28 offen offset:64 sc1
    v_mfma_f32_16x16x32_bf16 v[40:43], a[96:99], v[192:195], v[40:43]
    v_mul_f32 v26, v26, v228
    v_mul_f32 v27, v27, v228
    v_mfma_f32_16x16x32_bf16 v[44:47], a[100:103], v[192:195], v[44:47]
    v_mul_f32 v28, v28, v228
    v_mul_f32 v29, v29, v228
    v_mfma_f32_16x16x32_bf16 v[48:51], a[104:107], v[192:195], v[48:51]
    v_mul_f32 v30, v30, v228
    v_mul_f32 v31, v31, v228
    v_mfma_f32_16x16x32_bf16 v[52:55], a[108:111], v[192:195], v[52:55]
    v_cvt_pk_bf16_f32 v112, v24, v25
    v_cvt_pk_bf16_f32 v113, v26, v27
    v_mfma_f32_16x16x32_bf16 v[56:59], a[112:115], v[192:195], v[56:59]
    v_cvt_pk_bf16_f32 v114, v28, v29
    v_cvt_pk_bf16_f32 v115, v30, v31
    v_mfma_f32_16x16x32_bf16 v[60:63], a[116:119], v[192:195], v[60:63]
    v_permlane16_swap_b32 v112, v114
    v_permlane16_swap_b32 v113, v115
    v_mfma_f32_16x16x32_bf16 v[64:67], a[120:123], v[192:195], v[64:67]
    v_exp_f32 v152, v152
    v_mfma_f32_16x16x32_bf16 v[68:71], a[124:127], v[192:195], v[68:71]
    v_exp_f32 v153, v153
    v_mfma_f32_16x16x32_bf16 a[136:139], a[128:131], v[192:195], a[136:139]
    v_exp_f32 v154, v154
    v_mfma_f32_16x16x32_bf16 v[168:171], a[32:35], v[136:139], v[208:211]
    v_exp_f32 v155, v155
    v_mfma_f32_16x16x32_bf16 v[172:175], a[48:51], v[136:139], v[208:211]
    v_exp_f32 v156, v156
    v_mfma_f32_16x16x32_bf16 v[168:171], a[36:39], v[140:143], v[168:171]
    v_exp_f32 v157, v157
    v_mfma_f32_16x16x32_bf16 v[172:175], a[52:55], v[140:143], v[172:175]
    v_exp_f32 v158, v158
    v_mfma_f32_16x16x32_bf16 v[168:171], a[40:43], v[144:147], v[168:171]
    buffer_store_dwordx4 v[112:115], v227, s[16:19], s28 offen offset:128 sc1
    v_mfma_f32_16x16x32_bf16 v[172:175], a[56:59], v[144:147], v[172:175]
    v_exp_f32 v159, v159
    v_mfma_f32_16x16x32_bf16 v[168:171], a[44:47], v[148:151], v[168:171]
    v_cvt_pk_bf16_f32 v252, v152, v153
    v_cvt_pk_bf16_f32 v253, v154, v155
    v_mfma_f32_16x16x32_bf16 v[172:175], a[60:63], v[148:151], v[172:175]
    v_cvt_pk_bf16_f32 v254, v156, v157
    v_cvt_pk_bf16_f32 v255, v158, v159
    v_mfma_f32_16x16x32_bf16 v[72:75], a[64:67], v[184:187], v[72:75]
    v_mul_f32 v32, v32, v228
    v_mul_f32 v33, v33, v228
    v_mfma_f32_16x16x32_bf16 v[76:79], a[68:71], v[184:187], v[76:79]
    v_mul_f32 v34, v34, v228
    v_mul_f32 v35, v35, v228
    v_mfma_f32_16x16x32_bf16 v[80:83], a[72:75], v[184:187], v[80:83]
    v_mul_f32 v36, v36, v228
    v_mul_f32 v37, v37, v228
    v_mfma_f32_16x16x32_bf16 v[84:87], a[76:79], v[184:187], v[84:87]
    v_mul_f32 v38, v38, v228
    v_mul_f32 v39, v39, v228
    v_mfma_f32_16x16x32_bf16 v[88:91], a[80:83], v[184:187], v[88:91]
    v_cvt_pk_bf16_f32 v116, v32, v33
    v_cvt_pk_bf16_f32 v117, v34, v35
    v_mfma_f32_16x16x32_bf16 v[92:95], a[84:87], v[184:187], v[92:95]
    v_cvt_pk_bf16_f32 v118, v36, v37
    v_cvt_pk_bf16_f32 v119, v38, v39
    v_mfma_f32_16x16x32_bf16 v[96:99], a[88:91], v[184:187], v[96:99]
    v_permlane16_swap_b32 v116, v118
    v_permlane16_swap_b32 v117, v119
    v_mfma_f32_16x16x32_bf16 v[100:103], a[92:95], v[184:187], v[100:103]
    v_exp_f32 v160, v160
    v_mfma_f32_16x16x32_bf16 a[140:143], a[128:131], v[184:187], a[140:143]
    v_exp_f32 v161, v161
    v_mfma_f32_16x16x32_bf16 a[136:139], a[128:131], v[248:251], a[136:139]
    v_exp_f32 v162, v162
    v_mfma_f32_16x16x32_bf16 a[136:139], a[128:131], v[252:255], a[136:139]
    buffer_store_dwordx4 v[116:119], v227, s[16:19], s28 offen offset:192 sc1
    v_mfma_f32_16x16x32_bf16 v[40:43], a[144:147], v[248:251], v[40:43]
    v_exp_f32 v163, v163
    v_mfma_f32_16x16x32_bf16 v[40:43], a[176:179], v[252:255], v[40:43]
    v_exp_f32 v164, v164
    v_mfma_f32_16x16x32_bf16 v[44:47], a[148:151], v[248:251], v[44:47]
    v_exp_f32 v165, v165
    v_mfma_f32_16x16x32_bf16 v[44:47], a[180:183], v[252:255], v[44:47]
    v_accvgpr_read_b32 v229, a136
    v_cvt_pk_bf16_f32 v176, v160, v161
    v_mfma_f32_16x16x32_bf16 v[48:51], a[152:155], v[248:251], v[48:51]
    v_cmp_ngt_f32 s[50:51], s58, v229
    v_cvt_pk_bf16_f32 v177, v162, v163
    v_mfma_f32_16x16x32_bf16 v[48:51], a[184:187], v[252:255], v[48:51]
    v_rcp_f32 v229, v229
    v_mfma_f32_16x16x32_bf16 v[52:55], a[156:159], v[248:251], v[52:55]
    v_exp_f32 v166, v166
    v_mfma_f32_16x16x32_bf16 v[52:55], a[188:191], v[252:255], v[52:55]
    v_exp_f32 v167, v167
    v_mfma_f32_16x16x32_bf16 v[56:59], a[160:163], v[248:251], v[56:59]
    v_mul_f32 v40, v40, v229
    v_mul_f32 v41, v41, v229
    v_mfma_f32_16x16x32_bf16 v[56:59], a[192:195], v[252:255], v[56:59]
    v_mul_f32 v42, v42, v229
    v_mul_f32 v43, v43, v229
    v_mfma_f32_16x16x32_bf16 v[60:63], a[164:167], v[248:251], v[60:63]
    v_mul_f32 v44, v44, v229
    v_mul_f32 v45, v45, v229
    v_mfma_f32_16x16x32_bf16 v[60:63], a[196:199], v[252:255], v[60:63]
    v_mul_f32 v46, v46, v229
    v_mul_f32 v47, v47, v229
    v_mfma_f32_16x16x32_bf16 v[64:67], a[168:171], v[248:251], v[64:67]
    v_cvt_pk_bf16_f32 v120, v40, v41
    v_cvt_pk_bf16_f32 v121, v42, v43
    v_mfma_f32_16x16x32_bf16 v[64:67], a[200:203], v[252:255], v[64:67]
    v_cvt_pk_bf16_f32 v122, v44, v45
    v_cvt_pk_bf16_f32 v123, v46, v47
    v_mfma_f32_16x16x32_bf16 v[68:71], a[172:175], v[248:251], v[68:71]
    v_exp_f32 v168, v168
    v_exp_f32 v169, v169
    v_exp_f32 v170, v170
    v_exp_f32 v171, v171
    v_exp_f32 v172, v172
    v_exp_f32 v173, v173
    v_exp_f32 v174, v174
    v_exp_f32 v175, v175
    v_permlane16_swap_b32 v120, v122
    v_permlane16_swap_b32 v121, v123
    buffer_store_dwordx4 v[120:123], v227, s[16:19], s29 offen offset:0 sc1
    v_mfma_f32_16x16x32_bf16 v[68:71], a[204:207], v[252:255], v[68:71]
    v_cvt_pk_bf16_f32 v178, v164, v165
    v_cvt_pk_bf16_f32 v179, v166, v167
    v_mfma_f32_16x16x32_bf16 a[140:143], a[128:131], v[196:199], a[140:143]
    v_cvt_pk_bf16_f32 v188, v168, v169
    v_cvt_pk_bf16_f32 v189, v170, v171
    v_cvt_pk_bf16_f32 v190, v172, v173
    v_cvt_pk_bf16_f32 v191, v174, v175
    v_mfma_f32_16x16x32_bf16 a[140:143], a[128:131], v[176:179], a[140:143]
    v_mul_f32 v48, v48, v229
    v_mul_f32 v49, v49, v229
    v_mfma_f32_16x16x32_bf16 a[140:143], a[128:131], v[188:191], a[140:143]
    v_mul_f32 v50, v50, v229
    v_mul_f32 v51, v51, v229
    v_mfma_f32_16x16x32_bf16 v[72:75], a[96:99], v[196:199], v[72:75]
    v_mul_f32 v52, v52, v229
    v_mul_f32 v53, v53, v229
    v_mfma_f32_16x16x32_bf16 v[72:75], a[144:147], v[176:179], v[72:75]
    v_mul_f32 v54, v54, v229
    v_mul_f32 v55, v55, v229
    v_mfma_f32_16x16x32_bf16 v[72:75], a[176:179], v[188:191], v[72:75]
    v_cvt_pk_bf16_f32 v124, v48, v49
    v_cvt_pk_bf16_f32 v125, v50, v51
    v_mfma_f32_16x16x32_bf16 v[76:79], a[100:103], v[196:199], v[76:79]
    v_cvt_pk_bf16_f32 v126, v52, v53
    v_cvt_pk_bf16_f32 v127, v54, v55
    v_mfma_f32_16x16x32_bf16 v[76:79], a[148:151], v[176:179], v[76:79]
    v_permlane16_swap_b32 v124, v126
    v_permlane16_swap_b32 v125, v127
    v_mfma_f32_16x16x32_bf16 v[76:79], a[180:183], v[188:191], v[76:79]
    v_accvgpr_read_b32 v230, a140
    v_mul_f32 v56, v56, v229
    v_mfma_f32_16x16x32_bf16 v[80:83], a[104:107], v[196:199], v[80:83]
    v_cmp_ngt_f32 s[52:53], s58, v230
    v_mul_f32 v57, v57, v229
    v_mfma_f32_16x16x32_bf16 v[80:83], a[152:155], v[176:179], v[80:83]
    v_rcp_f32 v230, v230
    v_mfma_f32_16x16x32_bf16 v[80:83], a[184:187], v[188:191], v[80:83]
    buffer_store_dwordx4 v[124:127], v227, s[16:19], s29 offen offset:64 sc1
    v_mfma_f32_16x16x32_bf16 v[84:87], a[108:111], v[196:199], v[84:87]
    v_mul_f32 v58, v58, v229
    v_mul_f32 v59, v59, v229
    v_mfma_f32_16x16x32_bf16 v[84:87], a[156:159], v[176:179], v[84:87]
    v_mul_f32 v60, v60, v229
    v_mul_f32 v61, v61, v229
    v_mfma_f32_16x16x32_bf16 v[84:87], a[188:191], v[188:191], v[84:87]
    v_mul_f32 v62, v62, v229
    v_mul_f32 v63, v63, v229
    v_mfma_f32_16x16x32_bf16 v[88:91], a[112:115], v[196:199], v[88:91]
    v_mul_f32 v64, v64, v229
    v_mul_f32 v65, v65, v229
    v_mfma_f32_16x16x32_bf16 v[88:91], a[160:163], v[176:179], v[88:91]
    v_mul_f32 v66, v66, v229
    v_mul_f32 v67, v67, v229
    v_mfma_f32_16x16x32_bf16 v[88:91], a[192:195], v[188:191], v[88:91]
    v_mul_f32 v68, v68, v229
    v_mul_f32 v69, v69, v229
    v_mfma_f32_16x16x32_bf16 v[92:95], a[116:119], v[196:199], v[92:95]
    v_mul_f32 v70, v70, v229
    v_mul_f32 v71, v71, v229
    v_mfma_f32_16x16x32_bf16 v[92:95], a[164:167], v[176:179], v[92:95]
    v_cvt_pk_bf16_f32 v128, v56, v57
    v_cvt_pk_bf16_f32 v129, v58, v59
    v_mfma_f32_16x16x32_bf16 v[92:95], a[196:199], v[188:191], v[92:95]
    v_cvt_pk_bf16_f32 v130, v60, v61
    v_cvt_pk_bf16_f32 v131, v62, v63
    v_mfma_f32_16x16x32_bf16 v[96:99], a[120:123], v[196:199], v[96:99]
    v_cvt_pk_bf16_f32 v132, v64, v65
    v_cvt_pk_bf16_f32 v133, v66, v67
    v_mfma_f32_16x16x32_bf16 v[96:99], a[168:171], v[176:179], v[96:99]
    v_cvt_pk_bf16_f32 v134, v68, v69
    v_cvt_pk_bf16_f32 v135, v70, v71
    v_mfma_f32_16x16x32_bf16 v[96:99], a[200:203], v[188:191], v[96:99]
    v_mul_f32 v72, v72, v230
    v_mul_f32 v73, v73, v230
    v_mfma_f32_16x16x32_bf16 v[100:103], a[124:127], v[196:199], v[100:103]
    v_mul_f32 v74, v74, v230
    v_mul_f32 v75, v75, v230
    v_mfma_f32_16x16x32_bf16 v[100:103], a[172:175], v[176:179], v[100:103]
    v_mul_f32 v76, v76, v230
    v_mul_f32 v77, v77, v230
    v_mfma_f32_16x16x32_bf16 v[100:103], a[204:207], v[188:191], v[100:103]
    v_mul_f32 v78, v78, v230
    v_mul_f32 v79, v79, v230
    v_mul_f32 v80, v80, v230
    v_mul_f32 v81, v81, v230
    v_mul_f32 v82, v82, v230
    v_mul_f32 v83, v83, v230
    v_mul_f32 v84, v84, v230
    v_mul_f32 v85, v85, v230
    v_mul_f32 v86, v86, v230
    v_mul_f32 v87, v87, v230
    v_cvt_pk_bf16_f32 v136, v72, v73
    v_cvt_pk_bf16_f32 v137, v74, v75
    v_cvt_pk_bf16_f32 v138, v76, v77
    v_cvt_pk_bf16_f32 v139, v78, v79
    v_mul_f32 v88, v88, v230
    v_mul_f32 v89, v89, v230
    v_mul_f32 v90, v90, v230
    v_mul_f32 v91, v91, v230
    v_mul_f32 v92, v92, v230
    v_mul_f32 v93, v93, v230
    v_mul_f32 v94, v94, v230
    v_mul_f32 v95, v95, v230
    v_cvt_pk_bf16_f32 v140, v80, v81
    v_cvt_pk_bf16_f32 v141, v82, v83
    v_cvt_pk_bf16_f32 v142, v84, v85
    v_cvt_pk_bf16_f32 v143, v86, v87
    v_cvt_pk_bf16_f32 v144, v88, v89
    v_cvt_pk_bf16_f32 v145, v90, v91
    v_cvt_pk_bf16_f32 v146, v92, v93
    v_cvt_pk_bf16_f32 v147, v94, v95
    v_permlane16_swap_b32 v128, v130
    v_permlane16_swap_b32 v129, v131
    v_permlane16_swap_b32 v132, v134
    v_permlane16_swap_b32 v133, v135
    v_mul_f32 v96, v96, v230
    v_mul_f32 v97, v97, v230
    v_cvt_pk_bf16_f32 v148, v96, v97
    v_mul_f32 v98, v98, v230
    v_mul_f32 v99, v99, v230
    v_cvt_pk_bf16_f32 v149, v98, v99
    v_mul_f32 v100, v100, v230
    v_mul_f32 v101, v101, v230
    v_cvt_pk_bf16_f32 v150, v100, v101
    v_mul_f32 v102, v102, v230
    v_mul_f32 v103, v103, v230
    v_cvt_pk_bf16_f32 v151, v102, v103
    v_permlane16_swap_b32 v136, v138
    v_permlane16_swap_b32 v137, v139
    v_permlane16_swap_b32 v140, v142
    v_permlane16_swap_b32 v141, v143
    v_permlane16_swap_b32 v144, v146
    v_permlane16_swap_b32 v145, v147
    v_permlane16_swap_b32 v148, v150
    v_permlane16_swap_b32 v149, v151
    buffer_store_dwordx4 v[128:131], v227, s[16:19], s29 offen offset:128 sc1
    buffer_store_dwordx4 v[132:135], v227, s[16:19], s29 offen offset:192 sc1
    buffer_store_dwordx4 v[136:139], v227, s[16:19], s30 offen offset:0 sc1
    buffer_store_dwordx4 v[140:143], v227, s[16:19], s30 offen offset:64 sc1
    buffer_store_dwordx4 v[144:147], v227, s[16:19], s30 offen offset:128 sc1
    buffer_store_dwordx4 v[148:151], v227, s[16:19], s30 offen offset:192 sc1
    s_or_b64 s[48:49], s[48:49], s[50:51]
    s_or_b64 s[48:49], s[48:49], s[52:53]
    s_cbranch_scc1 L_fb
L_end:
    s_endpgm
L_fb:
    s_waitcnt vmcnt(0) lgkmcnt(0)
    s_nop 7
    s_nop 7
    s_mov_b32 s10, 16777216
    s_mov_b32 s14, 16777216
    s_lshl_b32 s34, s31, 14
    s_add_u32 s34, s34, 49152
    s_cmp_ge_u32 s31, 2
    s_cselect_b32 s35, 49152, 0
    s_add_u32 s34, s34, s35
    buffer_load_dwordx4 v[104:107], v226, s[4:7], s28 offen offset:0
    buffer_load_dwordx4 v[108:111], v226, s[4:7], s28 offen offset:64
    buffer_load_dwordx4 v[112:115], v226, s[4:7], s28 offen offset:128
    buffer_load_dwordx4 v[116:119], v226, s[4:7], s28 offen offset:192
    buffer_load_dwordx4 v[120:123], v226, s[4:7], s29 offen offset:0
    buffer_load_dwordx4 v[124:127], v226, s[4:7], s29 offen offset:64
    buffer_load_dwordx4 v[128:131], v226, s[4:7], s29 offen offset:128
    buffer_load_dwordx4 v[132:135], v226, s[4:7], s29 offen offset:192
    buffer_load_dwordx4 v[136:139], v226, s[4:7], s30 offen offset:0
    buffer_load_dwordx4 v[140:143], v226, s[4:7], s30 offen offset:64
    buffer_load_dwordx4 v[144:147], v226, s[4:7], s30 offen offset:128
    buffer_load_dwordx4 v[148:151], v226, s[4:7], s30 offen offset:192
    s_waitcnt vmcnt(0)
    v_lshlrev_b32 v232, 16, v104
    v_and_b32 v233, 0xffff0000, v104
    v_lshlrev_b32 v234, 16, v105
    v_and_b32 v235, 0xffff0000, v105
    v_lshlrev_b32 v236, 16, v106
    v_and_b32 v237, 0xffff0000, v106
    v_lshlrev_b32 v238, 16, v107
    v_and_b32 v239, 0xffff0000, v107
    v_lshlrev_b32 v240, 16, v108
    v_and_b32 v241, 0xffff0000, v108
    v_lshlrev_b32 v242, 16, v109
    v_and_b32 v243, 0xffff0000, v109
    v_lshlrev_b32 v244, 16, v110
    v_and_b32 v245, 0xffff0000, v110
    v_lshlrev_b32 v246, 16, v111
    v_and_b32 v247, 0xffff0000, v111
    v_pk_mul_f32 v[232:233], v[232:233], s[44:45]
    v_pk_mul_f32 v[234:235], v[234:235], s[44:45]
    v_pk_mul_f32 v[236:237], v[236:237], s[44:45]
    v_pk_mul_f32 v[238:239], v[238:239], s[44:45]
    v_pk_mul_f32 v[240:241], v[240:241], s[44:45]
    v_pk_mul_f32 v[242:243], v[242:243], s[44:45]
    v_pk_mul_f32 v[244:245], v[244:245], s[44:45]
    v_pk_mul_f32 v[246:247], v[246:247], s[44:45]
    v_cvt_pk_bf16_f32 v104, v232, v233
    v_cvt_pk_bf16_f32 v105, v234, v235
    v_cvt_pk_bf16_f32 v106, v236, v237
    v_cvt_pk_bf16_f32 v107, v238, v239
    v_cvt_pk_bf16_f32 v108, v240, v241
    v_cvt_pk_bf16_f32 v109, v242, v243
    v_cvt_pk_bf16_f32 v110, v244, v245
    v_cvt_pk_bf16_f32 v111, v246, v247
    v_lshlrev_b32 v232, 16, v112
    v_and_b32 v233, 0xffff0000, v112
    v_lshlrev_b32 v234, 16, v113
    v_and_b32 v235, 0xffff0000, v113
    v_lshlrev_b32 v236, 16, v114
    v_and_b32 v237, 0xffff0000, v114
    v_lshlrev_b32 v238, 16, v115
    v_and_b32 v239, 0xffff0000, v115
    v_lshlrev_b32 v240, 16, v116
    v_and_b32 v241, 0xffff0000, v116
    v_lshlrev_b32 v242, 16, v117
    v_and_b32 v243, 0xffff0000, v117
    v_lshlrev_b32 v244, 16, v118
    v_and_b32 v245, 0xffff0000, v118
    v_lshlrev_b32 v246, 16, v119
    v_and_b32 v247, 0xffff0000, v119
    v_pk_mul_f32 v[232:233], v[232:233], s[44:45]
    v_pk_mul_f32 v[234:235], v[234:235], s[44:45]
    v_pk_mul_f32 v[236:237], v[236:237], s[44:45]
    v_pk_mul_f32 v[238:239], v[238:239], s[44:45]
    v_pk_mul_f32 v[240:241], v[240:241], s[44:45]
    v_pk_mul_f32 v[242:243], v[242:243], s[44:45]
    v_pk_mul_f32 v[244:245], v[244:245], s[44:45]
    v_pk_mul_f32 v[246:247], v[246:247], s[44:45]
    v_cvt_pk_bf16_f32 v112, v232, v233
    v_cvt_pk_bf16_f32 v113, v234, v235
    v_cvt_pk_bf16_f32 v114, v236, v237
    v_cvt_pk_bf16_f32 v115, v238, v239
    v_cvt_pk_bf16_f32 v116, v240, v241
    v_cvt_pk_bf16_f32 v117, v242, v243
    v_cvt_pk_bf16_f32 v118, v244, v245
    v_cvt_pk_bf16_f32 v119, v246, v247
    v_lshlrev_b32 v232, 16, v120
    v_and_b32 v233, 0xffff0000, v120
    v_lshlrev_b32 v234, 16, v121
    v_and_b32 v235, 0xffff0000, v121
    v_lshlrev_b32 v236, 16, v122
    v_and_b32 v237, 0xffff0000, v122
    v_lshlrev_b32 v238, 16, v123
    v_and_b32 v239, 0xffff0000, v123
    v_lshlrev_b32 v240, 16, v124
    v_and_b32 v241, 0xffff0000, v124
    v_lshlrev_b32 v242, 16, v125
    v_and_b32 v243, 0xffff0000, v125
    v_lshlrev_b32 v244, 16, v126
    v_and_b32 v245, 0xffff0000, v126
    v_lshlrev_b32 v246, 16, v127
    v_and_b32 v247, 0xffff0000, v127
    v_pk_mul_f32 v[232:233], v[232:233], s[44:45]
    v_pk_mul_f32 v[234:235], v[234:235], s[44:45]
    v_pk_mul_f32 v[236:237], v[236:237], s[44:45]
    v_pk_mul_f32 v[238:239], v[238:239], s[44:45]
    v_pk_mul_f32 v[240:241], v[240:241], s[44:45]
    v_pk_mul_f32 v[242:243], v[242:243], s[44:45]
    v_pk_mul_f32 v[244:245], v[244:245], s[44:45]
    v_pk_mul_f32 v[246:247], v[246:247], s[44:45]
    v_cvt_pk_bf16_f32 v120, v232, v233
    v_cvt_pk_bf16_f32 v121, v234, v235
    v_cvt_pk_bf16_f32 v122, v236, v237
    v_cvt_pk_bf16_f32 v123, v238, v239
    v_cvt_pk_bf16_f32 v124, v240, v241
    v_cvt_pk_bf16_f32 v125, v242, v243
    v_cvt_pk_bf16_f32 v126, v244, v245
    v_cvt_pk_bf16_f32 v127, v246, v247
    v_lshlrev_b32 v232, 16, v128
    v_and_b32 v233, 0xffff0000, v128
    v_lshlrev_b32 v234, 16, v129
    v_and_b32 v235, 0xffff0000, v129
    v_lshlrev_b32 v236, 16, v130
    v_and_b32 v237, 0xffff0000, v130
    v_lshlrev_b32 v238, 16, v131
    v_and_b32 v239, 0xffff0000, v131
    v_lshlrev_b32 v240, 16, v132
    v_and_b32 v241, 0xffff0000, v132
    v_lshlrev_b32 v242, 16, v133
    v_and_b32 v243, 0xffff0000, v133
    v_lshlrev_b32 v244, 16, v134
    v_and_b32 v245, 0xffff0000, v134
    v_lshlrev_b32 v246, 16, v135
    v_and_b32 v247, 0xffff0000, v135
    v_pk_mul_f32 v[232:233], v[232:233], s[44:45]
    v_pk_mul_f32 v[234:235], v[234:235], s[44:45]
    v_pk_mul_f32 v[236:237], v[236:237], s[44:45]
    v_pk_mul_f32 v[238:239], v[238:239], s[44:45]
    v_pk_mul_f32 v[240:241], v[240:241], s[44:45]
    v_pk_mul_f32 v[242:243], v[242:243], s[44:45]
    v_pk_mul_f32 v[244:245], v[244:245], s[44:45]
    v_pk_mul_f32 v[246:247], v[246:247], s[44:45]
    v_cvt_pk_bf16_f32 v128, v232, v233
    v_cvt_pk_bf16_f32 v129, v234, v235
    v_cvt_pk_bf16_f32 v130, v236, v237
    v_cvt_pk_bf16_f32 v131, v238, v239
    v_cvt_pk_bf16_f32 v132, v240, v241
    v_cvt_pk_bf16_f32 v133, v242, v243
    v_cvt_pk_bf16_f32 v134, v244, v245
    v_cvt_pk_bf16_f32 v135, v246, v247
    v_lshlrev_b32 v232, 16, v136
    v_and_b32 v233, 0xffff0000, v136
    v_lshlrev_b32 v234, 16, v137
    v_and_b32 v235, 0xffff0000, v137
    v_lshlrev_b32 v236, 16, v138
    v_and_b32 v237, 0xffff0000, v138
    v_lshlrev_b32 v238, 16, v139
    v_and_b32 v239, 0xffff0000, v139
    v_lshlrev_b32 v240, 16, v140
    v_and_b32 v241, 0xffff0000, v140
    v_lshlrev_b32 v242, 16, v141
    v_and_b32 v243, 0xffff0000, v141
    v_lshlrev_b32 v244, 16, v142
    v_and_b32 v245, 0xffff0000, v142
    v_lshlrev_b32 v246, 16, v143
    v_and_b32 v247, 0xffff0000, v143
    v_pk_mul_f32 v[232:233], v[232:233], s[44:45]
    v_pk_mul_f32 v[234:235], v[234:235], s[44:45]
    v_pk_mul_f32 v[236:237], v[236:237], s[44:45]
    v_pk_mul_f32 v[238:239], v[238:239], s[44:45]
    v_pk_mul_f32 v[240:241], v[240:241], s[44:45]
    v_pk_mul_f32 v[242:243], v[242:243], s[44:45]
    v_pk_mul_f32 v[244:245], v[244:245], s[44:45]
    v_pk_mul_f32 v[246:247], v[246:247], s[44:45]
    v_cvt_pk_bf16_f32 v136, v232, v233
    v_cvt_pk_bf16_f32 v137, v234, v235
    v_cvt_pk_bf16_f32 v138, v236, v237
    v_cvt_pk_bf16_f32 v139, v238, v239
    v_cvt_pk_bf16_f32 v140, v240, v241
    v_cvt_pk_bf16_f32 v141, v242, v243
    v_cvt_pk_bf16_f32 v142, v244, v245
    v_cvt_pk_bf16_f32 v143, v246, v247
    v_lshlrev_b32 v232, 16, v144
    v_and_b32 v233, 0xffff0000, v144
    v_lshlrev_b32 v234, 16, v145
    v_and_b32 v235, 0xffff0000, v145
    v_lshlrev_b32 v236, 16, v146
    v_and_b32 v237, 0xffff0000, v146
    v_lshlrev_b32 v238, 16, v147
    v_and_b32 v239, 0xffff0000, v147
    v_lshlrev_b32 v240, 16, v148
    v_and_b32 v241, 0xffff0000, v148
    v_lshlrev_b32 v242, 16, v149
    v_and_b32 v243, 0xffff0000, v149
    v_lshlrev_b32 v244, 16, v150
    v_and_b32 v245, 0xffff0000, v150
    v_lshlrev_b32 v246, 16, v151
    v_and_b32 v247, 0xffff0000, v151
    v_pk_mul_f32 v[232:233], v[232:233], s[44:45]
    v_pk_mul_f32 v[234:235], v[234:235], s[44:45]
    v_pk_mul_f32 v[236:237], v[236:237], s[44:45]
    v_pk_mul_f32 v[238:239], v[238:239], s[44:45]
    v_pk_mul_f32 v[240:241], v[240:241], s[44:45]
    v_pk_mul_f32 v[242:243], v[242:243], s[44:45]
    v_pk_mul_f32 v[244:245], v[244:245], s[44:45]
    v_pk_mul_f32 v[246:247], v[246:247], s[44:45]
    v_cvt_pk_bf16_f32 v144, v232, v233
    v_cvt_pk_bf16_f32 v145, v234, v235
    v_cvt_pk_bf16_f32 v146, v236, v237
    v_cvt_pk_bf16_f32 v147, v238, v239
    v_cvt_pk_bf16_f32 v148, v240, v241
    v_cvt_pk_bf16_f32 v149, v242, v243
    v_cvt_pk_bf16_f32 v150, v244, v245
    v_cvt_pk_bf16_f32 v151, v246, v247
    v_subrev_u32 v228, s33, v224
    v_xor_b32 v229, 128, v228
    v_and_b32 v4, 7, v0
    v_lshlrev_b32 v4, 1, v4
    v_xor_b32 v4, v1, v4
    v_lshlrev_b32 v4, 4, v4
    v_lshl_add_u32 v4, v2, 8, v4
    v_add_u32 v4, s34, v4
    v_xor_b32 v152, 0, v4
    v_xor_b32 v153, 64, v4
    v_xor_b32 v154, 128, v4
    v_xor_b32 v155, 192, v4
    v_bfe_u32 v4, v0, 2, 2
    v_lshl_add_u32 v4, v1, 2, v4
    v_and_b32 v5, 7, v4
    v_lshlrev_b32 v5, 1, v5
    v_bfe_u32 v6, v0, 1, 1
    v_xor_b32 v5, v5, v6
    v_lshlrev_b32 v5, 4, v5
    v_and_b32 v6, 1, v0
    v_lshl_add_u32 v5, v6, 3, v5
    v_lshl_add_u32 v4, v4, 8, v5
    v_add_u32 v4, s34, v4
    v_xor_b32 v156, 0, v4
    v_xor_b32 v157, 32, v4
    v_xor_b32 v158, 64, v4
    v_xor_b32 v159, 96, v4
    v_xor_b32 v160, 128, v4
    v_xor_b32 v161, 160, v4
    v_xor_b32 v162, 192, v4
    v_xor_b32 v163, 224, v4
    v_mov_b32 v188, 0xff800000
    v_mov_b32 v189, 0xff800000
    v_mov_b32 v190, 0xff800000
    s_mov_b32 s48, 0
    s_mov_b32 s49, s32
L_fb1:
    s_add_u32 m0, s34, 0
    s_nop 0
    buffer_load_dwordx4 v228, s[8:11], s49 offen offset:0 lds
    buffer_load_dwordx4 v229, s[8:11], s49 offen offset:1024 lds
    buffer_load_dwordx4 v228, s[8:11], s49 offen offset:2048 lds
    buffer_load_dwordx4 v229, s[8:11], s49 offen offset:3072 lds
    s_add_u32 m0, s34, 4096
    s_add_u32 s50, s49, 4096
    buffer_load_dwordx4 v228, s[8:11], s50 offen offset:0 lds
    buffer_load_dwordx4 v229, s[8:11], s50 offen offset:1024 lds
    buffer_load_dwordx4 v228, s[8:11], s50 offen offset:2048 lds
    buffer_load_dwordx4 v229, s[8:11], s50 offen offset:3072 lds
    s_waitcnt vmcnt(0)
    ds_read_b128 a[0:3], v152 offset:0
    ds_read_b128 a[4:7], v153 offset:0
    ds_read_b128 a[8:11], v154 offset:0
    ds_read_b128 a[12:15], v155 offset:0
    ds_read_b128 a[16:19], v152 offset:4096
    ds_read_b128 a[20:23], v153 offset:4096
    ds_read_b128 a[24:27], v154 offset:4096
    ds_read_b128 a[28:31], v155 offset:4096
    s_waitcnt lgkmcnt(0)
    v_mfma_f32_16x16x32_bf16 v[176:179], a[0:3], v[104:107], 0
    v_mfma_f32_16x16x32_bf16 v[176:179], a[4:7], v[108:111], v[176:179]
    v_mfma_f32_16x16x32_bf16 v[176:179], a[8:11], v[112:115], v[176:179]
    v_mfma_f32_16x16x32_bf16 v[176:179], a[12:15], v[116:119], v[176:179]
    v_mfma_f32_16x16x32_bf16 v[180:183], a[16:19], v[104:107], 0
    v_mfma_f32_16x16x32_bf16 v[180:183], a[20:23], v[108:111], v[180:183]
    v_mfma_f32_16x16x32_bf16 v[180:183], a[24:27], v[112:115], v[180:183]
    v_mfma_f32_16x16x32_bf16 v[180:183], a[28:31], v[116:119], v[180:183]
    s_nop 7
    s_nop 7
    v_max3_f32 v188, v188, v176, v177
    v_max3_f32 v188, v188, v178, v179
    v_max3_f32 v188, v188, v180, v181
    v_max3_f32 v188, v188, v182, v183
    s_nop 3
    v_mfma_f32_16x16x32_bf16 v[176:179], a[0:3], v[120:123], 0
    v_mfma_f32_16x16x32_bf16 v[176:179], a[4:7], v[124:127], v[176:179]
    v_mfma_f32_16x16x32_bf16 v[176:179], a[8:11], v[128:131], v[176:179]
    v_mfma_f32_16x16x32_bf16 v[176:179], a[12:15], v[132:135], v[176:179]
    v_mfma_f32_16x16x32_bf16 v[180:183], a[16:19], v[120:123], 0
    v_mfma_f32_16x16x32_bf16 v[180:183], a[20:23], v[124:127], v[180:183]
    v_mfma_f32_16x16x32_bf16 v[180:183], a[24:27], v[128:131], v[180:183]
    v_mfma_f32_16x16x32_bf16 v[180:183], a[28:31], v[132:135], v[180:183]
    s_nop 7
    s_nop 7
    v_max3_f32 v189, v189, v176, v177
    v_max3_f32 v189, v189, v178, v179
    v_max3_f32 v189, v189, v180, v181
    v_max3_f32 v189, v189, v182, v183
    s_nop 3
    v_mfma_f32_16x16x32_bf16 v[176:179], a[0:3], v[136:139], 0
    v_mfma_f32_16x16x32_bf16 v[176:179], a[4:7], v[140:143], v[176:179]
    v_mfma_f32_16x16x32_bf16 v[176:179], a[8:11], v[144:147], v[176:179]
    v_mfma_f32_16x16x32_bf16 v[176:179], a[12:15], v[148:151], v[176:179]
    v_mfma_f32_16x16x32_bf16 v[180:183], a[16:19], v[136:139], 0
    v_mfma_f32_16x16x32_bf16 v[180:183], a[20:23], v[140:143], v[180:183]
    v_mfma_f32_16x16x32_bf16 v[180:183], a[24:27], v[144:147], v[180:183]
    v_mfma_f32_16x16x32_bf16 v[180:183], a[28:31], v[148:151], v[180:183]
    s_nop 7
    s_nop 7
    v_max3_f32 v190, v190, v176, v177
    v_max3_f32 v190, v190, v178, v179
    v_max3_f32 v190, v190, v180, v181
    v_max3_f32 v190, v190, v182, v183
    s_nop 3
    s_add_u32 s49, s49, 8192
    s_add_u32 s48, s48, 1
    s_cmp_lt_u32 s48, 16
    s_cbranch_scc1 L_fb1
    v_mov_b32 v192, v188
    s_nop 1
    v_permlane16_swap_b32 v188, v192
    v_max_f32 v188, v188, v192
    v_mov_b32 v192, v188
    s_nop 1
    v_permlane32_swap_b32 v188, v192
    v_max_f32 v188, v188, v192
    v_sub_f32 v200, 0, v188
    v_sub_f32 v201, 0, v188
    v_sub_f32 v202, 0, v188
    v_sub_f32 v203, 0, v188
    v_mov_b32 v192, v189
    s_nop 1
    v_permlane16_swap_b32 v189, v192
    v_max_f32 v189, v189, v192
    v_mov_b32 v192, v189
    s_nop 1
    v_permlane32_swap_b32 v189, v192
    v_max_f32 v189, v189, v192
    v_sub_f32 v204, 0, v189
    v_sub_f32 v205, 0, v189
    v_sub_f32 v206, 0, v189
    v_sub_f32 v207, 0, v189
    v_mov_b32 v192, v190
    s_nop 1
    v_permlane16_swap_b32 v190, v192
    v_max_f32 v190, v190, v192
    v_mov_b32 v192, v190
    s_nop 1
    v_permlane32_swap_b32 v190, v192
    v_max_f32 v190, v190, v192
    v_sub_f32 v208, 0, v190
    v_sub_f32 v209, 0, v190
    v_sub_f32 v210, 0, v190
    v_sub_f32 v211, 0, v190
    v_mov_b32 v8, 0
    v_mov_b32 v9, 0
    v_mov_b32 v10, 0
    v_mov_b32 v11, 0
    v_mov_b32 v12, 0
    v_mov_b32 v13, 0
    v_mov_b32 v14, 0
    v_mov_b32 v15, 0
    v_mov_b32 v16, 0
    v_mov_b32 v17, 0
    v_mov_b32 v18, 0
    v_mov_b32 v19, 0
    v_mov_b32 v20, 0
    v_mov_b32 v21, 0
    v_mov_b32 v22, 0
    v_mov_b32 v23, 0
    v_mov_b32 v24, 0
    v_mov_b32 v25, 0
    v_mov_b32 v26, 0
    v_mov_b32 v27, 0
    v_mov_b32 v28, 0
    v_mov_b32 v29, 0
    v_mov_b32 v30, 0
    v_mov_b32 v31, 0
    v_mov_b32 v32, 0
    v_mov_b32 v33, 0
    v_mov_b32 v34, 0
    v_mov_b32 v35, 0
    v_mov_b32 v36, 0
    v_mov_b32 v37, 0
    v_mov_b32 v38, 0
    v_mov_b32 v39, 0
    v_mov_b32 v40, 0
    v_mov_b32 v41, 0
    v_mov_b32 v42, 0
    v_mov_b32 v43, 0
    v_mov_b32 v44, 0
    v_mov_b32 v45, 0
    v_mov_b32 v46, 0
    v_mov_b32 v47, 0
    v_mov_b32 v48, 0
    v_mov_b32 v49, 0
    v_mov_b32 v50, 0
    v_mov_b32 v51, 0
    v_mov_b32 v52, 0
    v_mov_b32 v53, 0
    v_mov_b32 v54, 0
    v_mov_b32 v55, 0
    v_mov_b32 v56, 0
    v_mov_b32 v57, 0
    v_mov_b32 v58, 0
    v_mov_b32 v59, 0
    v_mov_b32 v60, 0
    v_mov_b32 v61, 0
    v_mov_b32 v62, 0
    v_mov_b32 v63, 0
    v_mov_b32 v64, 0
    v_mov_b32 v65, 0
    v_mov_b32 v66, 0
    v_mov_b32 v67, 0
    v_mov_b32 v68, 0
    v_mov_b32 v69, 0
    v_mov_b32 v70, 0
    v_mov_b32 v71, 0
    v_mov_b32 v72, 0
    v_mov_b32 v73, 0
    v_mov_b32 v74, 0
    v_mov_b32 v75, 0
    v_mov_b32 v76, 0
    v_mov_b32 v77, 0
    v_mov_b32 v78, 0
    v_mov_b32 v79, 0
    v_mov_b32 v80, 0
    v_mov_b32 v81, 0
    v_mov_b32 v82, 0
    v_mov_b32 v83, 0
    v_mov_b32 v84, 0
    v_mov_b32 v85, 0
    v_mov_b32 v86, 0
    v_mov_b32 v87, 0
    v_mov_b32 v88, 0
    v_mov_b32 v89, 0
    v_mov_b32 v90, 0
    v_mov_b32 v91, 0
    v_mov_b32 v92, 0
    v_mov_b32 v93, 0
    v_mov_b32 v94, 0
    v_mov_b32 v95, 0
    v_mov_b32 v96, 0
    v_mov_b32 v97, 0
    v_mov_b32 v98, 0
    v_mov_b32 v99, 0
    v_mov_b32 v100, 0
    v_mov_b32 v101, 0
    v_mov_b32 v102, 0
    v_mov_b32 v103, 0
    v_accvgpr_write_b32 a132, 0
    v_accvgpr_write_b32 a133, 0
    v_accvgpr_write_b32 a134, 0
    v_accvgpr_write_b32 a135, 0
    v_accvgpr_write_b32 a136, 0
    v_accvgpr_write_b32 a137, 0
    v_accvgpr_write_b32 a138, 0
    v_accvgpr_write_b32 a139, 0
    v_accvgpr_write_b32 a140, 0
    v_accvgpr_write_b32 a141, 0
    v_accvgpr_write_b32 a142, 0
    v_accvgpr_write_b32 a143, 0
    s_mov_b32 s48, 0
    s_mov_b32 s49, s32
L_fb2:
    s_add_u32 m0, s34, 0
    s_nop 0
    buffer_load_dwordx4 v228, s[8:11], s49 offen offset:0 lds
    buffer_load_dwordx4 v229, s[8:11], s49 offen offset:1024 lds
    buffer_load_dwordx4 v228, s[8:11], s49 offen offset:2048 lds
    buffer_load_dwordx4 v229, s[8:11], s49 offen offset:3072 lds
    s_add_u32 m0, s34, 4096
    s_add_u32 s50, s49, 4096
    buffer_load_dwordx4 v228, s[8:11], s50 offen offset:0 lds
    buffer_load_dwordx4 v229, s[8:11], s50 offen offset:1024 lds
    buffer_load_dwordx4 v228, s[8:11], s50 offen offset:2048 lds
    buffer_load_dwordx4 v229, s[8:11], s50 offen offset:3072 lds
    s_add_u32 m0, s34, 8192
    s_nop 0
    buffer_load_dwordx4 v228, s[12:15], s49 offen offset:0 lds
    buffer_load_dwordx4 v229, s[12:15], s49 offen offset:1024 lds
    buffer_load_dwordx4 v228, s[12:15], s49 offen offset:2048 lds
    buffer_load_dwordx4 v229, s[12:15], s49 offen offset:3072 lds
    s_add_u32 m0, s34, 12288
    s_add_u32 s50, s49, 4096
    buffer_load_dwordx4 v228, s[12:15], s50 offen offset:0 lds
    buffer_load_dwordx4 v229, s[12:15], s50 offen offset:1024 lds
    buffer_load_dwordx4 v228, s[12:15], s50 offen offset:2048 lds
    buffer_load_dwordx4 v229, s[12:15], s50 offen offset:3072 lds
    s_waitcnt vmcnt(0)
    ds_read_b128 a[0:3], v152 offset:0
    ds_read_b128 a[4:7], v153 offset:0
    ds_read_b128 a[8:11], v154 offset:0
    ds_read_b128 a[12:15], v155 offset:0
    ds_read_b128 a[16:19], v152 offset:4096
    ds_read_b128 a[20:23], v153 offset:4096
    ds_read_b128 a[24:27], v154 offset:4096
    ds_read_b128 a[28:31], v155 offset:4096
    ds_read_b64_tr_b16 a[64:65], v156 offset:8192
    ds_read_b64_tr_b16 a[66:67], v156 offset:12288
    ds_read_b64_tr_b16 a[68:69], v157 offset:8192
    ds_read_b64_tr_b16 a[70:71], v157 offset:12288
    ds_read_b64_tr_b16 a[72:73], v158 offset:8192
    ds_read_b64_tr_b16 a[74:75], v158 offset:12288
    ds_read_b64_tr_b16 a[76:77], v159 offset:8192
    ds_read_b64_tr_b16 a[78:79], v159 offset:12288
    ds_read_b64_tr_b16 a[80:81], v160 offset:8192
    ds_read_b64_tr_b16 a[82:83], v160 offset:12288
    ds_read_b64_tr_b16 a[84:85], v161 offset:8192
    ds_read_b64_tr_b16 a[86:87], v161 offset:12288
    ds_read_b64_tr_b16 a[88:89], v162 offset:8192
    ds_read_b64_tr_b16 a[90:91], v162 offset:12288
    ds_read_b64_tr_b16 a[92:93], v163 offset:8192
    ds_read_b64_tr_b16 a[94:95], v163 offset:12288
    s_waitcnt lgkmcnt(0)
    v_mfma_f32_16x16x32_bf16 v[176:179], a[0:3], v[104:107], v[200:203]
    v_mfma_f32_16x16x32_bf16 v[176:179], a[4:7], v[108:111], v[176:179]
    v_mfma_f32_16x16x32_bf16 v[176:179], a[8:11], v[112:115], v[176:179]
    v_mfma_f32_16x16x32_bf16 v[176:179], a[12:15], v[116:119], v[176:179]
    v_mfma_f32_16x16x32_bf16 v[180:183], a[16:19], v[104:107], v[200:203]
    v_mfma_f32_16x16x32_bf16 v[180:183], a[20:23], v[108:111], v[180:183]
    v_mfma_f32_16x16x32_bf16 v[180:183], a[24:27], v[112:115], v[180:183]
    v_mfma_f32_16x16x32_bf16 v[180:183], a[28:31], v[116:119], v[180:183]
    s_nop 7
    s_nop 7
    v_exp_f32 v176, v176
    v_exp_f32 v177, v177
    v_exp_f32 v178, v178
    v_exp_f32 v179, v179
    v_exp_f32 v180, v180
    v_exp_f32 v181, v181
    v_exp_f32 v182, v182
    v_exp_f32 v183, v183
    s_nop 1
    v_cvt_pk_bf16_f32 v184, v176, v177
    v_cvt_pk_bf16_f32 v185, v178, v179
    v_cvt_pk_bf16_f32 v186, v180, v181
    v_cvt_pk_bf16_f32 v187, v182, v183
    s_nop 1
    v_mfma_f32_16x16x32_bf16 v[8:11], a[64:67], v[184:187], v[8:11]
    v_mfma_f32_16x16x32_bf16 v[12:15], a[68:71], v[184:187], v[12:15]
    v_mfma_f32_16x16x32_bf16 v[16:19], a[72:75], v[184:187], v[16:19]
    v_mfma_f32_16x16x32_bf16 v[20:23], a[76:79], v[184:187], v[20:23]
    v_mfma_f32_16x16x32_bf16 v[24:27], a[80:83], v[184:187], v[24:27]
    v_mfma_f32_16x16x32_bf16 v[28:31], a[84:87], v[184:187], v[28:31]
    v_mfma_f32_16x16x32_bf16 v[32:35], a[88:91], v[184:187], v[32:35]
    v_mfma_f32_16x16x32_bf16 v[36:39], a[92:95], v[184:187], v[36:39]
    v_mfma_f32_16x16x32_bf16 a[132:135], a[128:131], v[184:187], a[132:135]
    s_nop 7
    v_mfma_f32_16x16x32_bf16 v[176:179], a[0:3], v[120:123], v[204:207]
    v_mfma_f32_16x16x32_bf16 v[176:179], a[4:7], v[124:127], v[176:179]
    v_mfma_f32_16x16x32_bf16 v[176:179], a[8:11], v[128:131], v[176:179]
    v_mfma_f32_16x16x32_bf16 v[176:179], a[12:15], v[132:135], v[176:179]
    v_mfma_f32_16x16x32_bf16 v[180:183], a[16:19], v[120:123], v[204:207]
    v_mfma_f32_16x16x32_bf16 v[180:183], a[20:23], v[124:127], v[180:183]
    v_mfma_f32_16x16x32_bf16 v[180:183], a[24:27], v[128:131], v[180:183]
    v_mfma_f32_16x16x32_bf16 v[180:183], a[28:31], v[132:135], v[180:183]
    s_nop 7
    s_nop 7
    v_exp_f32 v176, v176
    v_exp_f32 v177, v177
    v_exp_f32 v178, v178
    v_exp_f32 v179, v179
    v_exp_f32 v180, v180
    v_exp_f32 v181, v181
    v_exp_f32 v182, v182
    v_exp_f32 v183, v183
    s_nop 1
    v_cvt_pk_bf16_f32 v184, v176, v177
    v_cvt_pk_bf16_f32 v185, v178, v179
    v_cvt_pk_bf16_f32 v186, v180, v181
    v_cvt_pk_bf16_f32 v187, v182, v183
    s_nop 1
    v_mfma_f32_16x16x32_bf16 v[40:43], a[64:67], v[184:187], v[40:43]
    v_mfma_f32_16x16x32_bf16 v[44:47], a[68:71], v[184:187], v[44:47]
    v_mfma_f32_16x16x32_bf16 v[48:51], a[72:75], v[184:187], v[48:51]
    v_mfma_f32_16x16x32_bf16 v[52:55], a[76:79], v[184:187], v[52:55]
    v_mfma_f32_16x16x32_bf16 v[56:59], a[80:83], v[184:187], v[56:59]
    v_mfma_f32_16x16x32_bf16 v[60:63], a[84:87], v[184:187], v[60:63]
    v_mfma_f32_16x16x32_bf16 v[64:67], a[88:91], v[184:187], v[64:67]
    v_mfma_f32_16x16x32_bf16 v[68:71], a[92:95], v[184:187], v[68:71]
    v_mfma_f32_16x16x32_bf16 a[136:139], a[128:131], v[184:187], a[136:139]
    s_nop 7
    v_mfma_f32_16x16x32_bf16 v[176:179], a[0:3], v[136:139], v[208:211]
    v_mfma_f32_16x16x32_bf16 v[176:179], a[4:7], v[140:143], v[176:179]
    v_mfma_f32_16x16x32_bf16 v[176:179], a[8:11], v[144:147], v[176:179]
    v_mfma_f32_16x16x32_bf16 v[176:179], a[12:15], v[148:151], v[176:179]
    v_mfma_f32_16x16x32_bf16 v[180:183], a[16:19], v[136:139], v[208:211]
    v_mfma_f32_16x16x32_bf16 v[180:183], a[20:23], v[140:143], v[180:183]
    v_mfma_f32_16x16x32_bf16 v[180:183], a[24:27], v[144:147], v[180:183]
    v_mfma_f32_16x16x32_bf16 v[180:183], a[28:31], v[148:151], v[180:183]
    s_nop 7
    s_nop 7
    v_exp_f32 v176, v176
    v_exp_f32 v177, v177
    v_exp_f32 v178, v178
    v_exp_f32 v179, v179
    v_exp_f32 v180, v180
    v_exp_f32 v181, v181
    v_exp_f32 v182, v182
    v_exp_f32 v183, v183
    s_nop 1
    v_cvt_pk_bf16_f32 v184, v176, v177
    v_cvt_pk_bf16_f32 v185, v178, v179
    v_cvt_pk_bf16_f32 v186, v180, v181
    v_cvt_pk_bf16_f32 v187, v182, v183
    s_nop 1
    v_mfma_f32_16x16x32_bf16 v[72:75], a[64:67], v[184:187], v[72:75]
    v_mfma_f32_16x16x32_bf16 v[76:79], a[68:71], v[184:187], v[76:79]
    v_mfma_f32_16x16x32_bf16 v[80:83], a[72:75], v[184:187], v[80:83]
    v_mfma_f32_16x16x32_bf16 v[84:87], a[76:79], v[184:187], v[84:87]
    v_mfma_f32_16x16x32_bf16 v[88:91], a[80:83], v[184:187], v[88:91]
    v_mfma_f32_16x16x32_bf16 v[92:95], a[84:87], v[184:187], v[92:95]
    v_mfma_f32_16x16x32_bf16 v[96:99], a[88:91], v[184:187], v[96:99]
    v_mfma_f32_16x16x32_bf16 v[100:103], a[92:95], v[184:187], v[100:103]
    v_mfma_f32_16x16x32_bf16 a[140:143], a[128:131], v[184:187], a[140:143]
    s_nop 7
    s_add_u32 s49, s49, 8192
    s_add_u32 s48, s48, 1
    s_cmp_lt_u32 s48, 16
    s_cbranch_scc1 L_fb2
    s_nop 7
    s_nop 7
    v_accvgpr_read_b32 v192, a132
    s_nop 1
    v_rcp_f32 v192, v192
    s_nop 1
    v_mul_f32 v8, v8, v192
    v_mul_f32 v9, v9, v192
    v_mul_f32 v10, v10, v192
    v_mul_f32 v11, v11, v192
    v_mul_f32 v12, v12, v192
    v_mul_f32 v13, v13, v192
    v_mul_f32 v14, v14, v192
    v_mul_f32 v15, v15, v192
    v_mul_f32 v16, v16, v192
    v_mul_f32 v17, v17, v192
    v_mul_f32 v18, v18, v192
    v_mul_f32 v19, v19, v192
    v_mul_f32 v20, v20, v192
    v_mul_f32 v21, v21, v192
    v_mul_f32 v22, v22, v192
    v_mul_f32 v23, v23, v192
    v_mul_f32 v24, v24, v192
    v_mul_f32 v25, v25, v192
    v_mul_f32 v26, v26, v192
    v_mul_f32 v27, v27, v192
    v_mul_f32 v28, v28, v192
    v_mul_f32 v29, v29, v192
    v_mul_f32 v30, v30, v192
    v_mul_f32 v31, v31, v192
    v_mul_f32 v32, v32, v192
    v_mul_f32 v33, v33, v192
    v_mul_f32 v34, v34, v192
    v_mul_f32 v35, v35, v192
    v_mul_f32 v36, v36, v192
    v_mul_f32 v37, v37, v192
    v_mul_f32 v38, v38, v192
    v_mul_f32 v39, v39, v192
    v_cvt_pk_bf16_f32 v104, v8, v9
    v_cvt_pk_bf16_f32 v105, v10, v11
    v_cvt_pk_bf16_f32 v106, v12, v13
    v_cvt_pk_bf16_f32 v107, v14, v15
    v_cvt_pk_bf16_f32 v108, v16, v17
    v_cvt_pk_bf16_f32 v109, v18, v19
    v_cvt_pk_bf16_f32 v110, v20, v21
    v_cvt_pk_bf16_f32 v111, v22, v23
    v_cvt_pk_bf16_f32 v112, v24, v25
    v_cvt_pk_bf16_f32 v113, v26, v27
    v_cvt_pk_bf16_f32 v114, v28, v29
    v_cvt_pk_bf16_f32 v115, v30, v31
    v_cvt_pk_bf16_f32 v116, v32, v33
    v_cvt_pk_bf16_f32 v117, v34, v35
    v_cvt_pk_bf16_f32 v118, v36, v37
    v_cvt_pk_bf16_f32 v119, v38, v39
    s_nop 1
    v_permlane16_swap_b32 v104, v106
    v_permlane16_swap_b32 v105, v107
    v_permlane16_swap_b32 v108, v110
    v_permlane16_swap_b32 v109, v111
    v_permlane16_swap_b32 v112, v114
    v_permlane16_swap_b32 v113, v115
    v_permlane16_swap_b32 v116, v118
    v_permlane16_swap_b32 v117, v119
    s_nop 1
    buffer_store_dwordx4 v[104:107], v227, s[16:19], s28 offen offset:0
    buffer_store_dwordx4 v[108:111], v227, s[16:19], s28 offen offset:64
    buffer_store_dwordx4 v[112:115], v227, s[16:19], s28 offen offset:128
    buffer_store_dwordx4 v[116:119], v227, s[16:19], s28 offen offset:192
    v_accvgpr_read_b32 v192, a136
    s_nop 1
    v_rcp_f32 v192, v192
    s_nop 1
    v_mul_f32 v40, v40, v192
    v_mul_f32 v41, v41, v192
    v_mul_f32 v42, v42, v192
    v_mul_f32 v43, v43, v192
    v_mul_f32 v44, v44, v192
    v_mul_f32 v45, v45, v192
    v_mul_f32 v46, v46, v192
    v_mul_f32 v47, v47, v192
    v_mul_f32 v48, v48, v192
    v_mul_f32 v49, v49, v192
    v_mul_f32 v50, v50, v192
    v_mul_f32 v51, v51, v192
    v_mul_f32 v52, v52, v192
    v_mul_f32 v53, v53, v192
    v_mul_f32 v54, v54, v192
    v_mul_f32 v55, v55, v192
    v_mul_f32 v56, v56, v192
    v_mul_f32 v57, v57, v192
    v_mul_f32 v58, v58, v192
    v_mul_f32 v59, v59, v192
    v_mul_f32 v60, v60, v192
    v_mul_f32 v61, v61, v192
    v_mul_f32 v62, v62, v192
    v_mul_f32 v63, v63, v192
    v_mul_f32 v64, v64, v192
    v_mul_f32 v65, v65, v192
    v_mul_f32 v66, v66, v192
    v_mul_f32 v67, v67, v192
    v_mul_f32 v68, v68, v192
    v_mul_f32 v69, v69, v192
    v_mul_f32 v70, v70, v192
    v_mul_f32 v71, v71, v192
    v_cvt_pk_bf16_f32 v120, v40, v41
    v_cvt_pk_bf16_f32 v121, v42, v43
    v_cvt_pk_bf16_f32 v122, v44, v45
    v_cvt_pk_bf16_f32 v123, v46, v47
    v_cvt_pk_bf16_f32 v124, v48, v49
    v_cvt_pk_bf16_f32 v125, v50, v51
    v_cvt_pk_bf16_f32 v126, v52, v53
    v_cvt_pk_bf16_f32 v127, v54, v55
    v_cvt_pk_bf16_f32 v128, v56, v57
    v_cvt_pk_bf16_f32 v129, v58, v59
    v_cvt_pk_bf16_f32 v130, v60, v61
    v_cvt_pk_bf16_f32 v131, v62, v63
    v_cvt_pk_bf16_f32 v132, v64, v65
    v_cvt_pk_bf16_f32 v133, v66, v67
    v_cvt_pk_bf16_f32 v134, v68, v69
    v_cvt_pk_bf16_f32 v135, v70, v71
    s_nop 1
    v_permlane16_swap_b32 v120, v122
    v_permlane16_swap_b32 v121, v123
    v_permlane16_swap_b32 v124, v126
    v_permlane16_swap_b32 v125, v127
    v_permlane16_swap_b32 v128, v130
    v_permlane16_swap_b32 v129, v131
    v_permlane16_swap_b32 v132, v134
    v_permlane16_swap_b32 v133, v135
    s_nop 1
    buffer_store_dwordx4 v[120:123], v227, s[16:19], s29 offen offset:0
    buffer_store_dwordx4 v[124:127], v227, s[16:19], s29 offen offset:64
    buffer_store_dwordx4 v[128:131], v227, s[16:19], s29 offen offset:128
    buffer_store_dwordx4 v[132:135], v227, s[16:19], s29 offen offset:192
    v_accvgpr_read_b32 v192, a140
    s_nop 1
    v_rcp_f32 v192, v192
    s_nop 1
    v_mul_f32 v72, v72, v192
    v_mul_f32 v73, v73, v192
    v_mul_f32 v74, v74, v192
    v_mul_f32 v75, v75, v192
    v_mul_f32 v76, v76, v192
    v_mul_f32 v77, v77, v192
    v_mul_f32 v78, v78, v192
    v_mul_f32 v79, v79, v192
    v_mul_f32 v80, v80, v192
    v_mul_f32 v81, v81, v192
    v_mul_f32 v82, v82, v192
    v_mul_f32 v83, v83, v192
    v_mul_f32 v84, v84, v192
    v_mul_f32 v85, v85, v192
    v_mul_f32 v86, v86, v192
    v_mul_f32 v87, v87, v192
    v_mul_f32 v88, v88, v192
    v_mul_f32 v89, v89, v192
    v_mul_f32 v90, v90, v192
    v_mul_f32 v91, v91, v192
    v_mul_f32 v92, v92, v192
    v_mul_f32 v93, v93, v192
    v_mul_f32 v94, v94, v192
    v_mul_f32 v95, v95, v192
    v_mul_f32 v96, v96, v192
    v_mul_f32 v97, v97, v192
    v_mul_f32 v98, v98, v192
    v_mul_f32 v99, v99, v192
    v_mul_f32 v100, v100, v192
    v_mul_f32 v101, v101, v192
    v_mul_f32 v102, v102, v192
    v_mul_f32 v103, v103, v192
    v_cvt_pk_bf16_f32 v136, v72, v73
    v_cvt_pk_bf16_f32 v137, v74, v75
    v_cvt_pk_bf16_f32 v138, v76, v77
    v_cvt_pk_bf16_f32 v139, v78, v79
    v_cvt_pk_bf16_f32 v140, v80, v81
    v_cvt_pk_bf16_f32 v141, v82, v83
    v_cvt_pk_bf16_f32 v142, v84, v85
    v_cvt_pk_bf16_f32 v143, v86, v87
    v_cvt_pk_bf16_f32 v144, v88, v89
    v_cvt_pk_bf16_f32 v145, v90, v91
    v_cvt_pk_bf16_f32 v146, v92, v93
    v_cvt_pk_bf16_f32 v147, v94, v95
    v_cvt_pk_bf16_f32 v148, v96, v97
    v_cvt_pk_bf16_f32 v149, v98, v99
    v_cvt_pk_bf16_f32 v150, v100, v101
    v_cvt_pk_bf16_f32 v151, v102, v103
    s_nop 1
    v_permlane16_swap_b32 v136, v138
    v_permlane16_swap_b32 v137, v139
    v_permlane16_swap_b32 v140, v142
    v_permlane16_swap_b32 v141, v143
    v_permlane16_swap_b32 v144, v146
    v_permlane16_swap_b32 v145, v147
    v_permlane16_swap_b32 v148, v150
    v_permlane16_swap_b32 v149, v151
    s_nop 1
    buffer_store_dwordx4 v[136:139], v227, s[16:19], s30 offen offset:0
    buffer_store_dwordx4 v[140:143], v227, s[16:19], s30 offen offset:64
    buffer_store_dwordx4 v[144:147], v227, s[16:19], s30 offen offset:128
    buffer_store_dwordx4 v[148:151], v227, s[16:19], s30 offen offset:192
    s_endpgm

.section .rodata,"a"
.p2align 6
.amdhsa_kernel standalone__gqa_softmax__near_ridge_kernel
  .amdhsa_next_free_vgpr 464
  .amdhsa_next_free_sgpr 96
  .amdhsa_accum_offset 256
  .amdhsa_group_segment_fixed_size 0
  .amdhsa_kernarg_size 48
  .amdhsa_user_sgpr_count 2
  .amdhsa_user_sgpr_kernarg_segment_ptr 1
  .amdhsa_system_sgpr_workgroup_id_x 1
  .amdhsa_float_denorm_mode_32 3
.end_amdhsa_kernel
```
